```python
import torch

def _softmax(x, axis=-1):
    return torch.softmax(x, dim=axis)
def _gelu(x):
    return torch.nn.functional.gelu(x, approximate="tanh")
def _silu(x):
    return torch.nn.functional.silu(x)
def _sigmoid(x):
    return torch.sigmoid(x)
def _layernorm(x, axis=-1, eps=1e-5):
    m = x.mean(dim=axis, keepdim=True)
    v = x.var(dim=axis, keepdim=True, unbiased=False)
    return (x - m) / torch.sqrt(v + eps)
def _scatter_add(tgt, idx, src, axis=0):
    return tgt.clone().index_add_(axis, idx, src)
def _segment_sum(src, seg, n):
    out = torch.zeros((n,) + src.shape[1:], dtype=src.dtype)
    return out.index_add_(0, seg, src)
def _pad(x, pw):
    flat = tuple(v for pair in reversed(pw) for v in pair)
    return torch.nn.functional.pad(x, flat)

kernel_name = 'concat_heads__sliding_block__sliding_block__prompt'

def setup_inputs():

    _w = (lambda a: (lambda t: t.to(torch.bfloat16) if t.is_floating_point() else t)(torch.as_tensor(a)))
    def _A_setup():
        B, S, D = 1, 2048, 512
        return {
            "x": _w((lambda *s: torch.randn(*s, dtype=torch.bfloat16) * 0.2)(B, S, D)),
            "wqkv": _w((lambda *s: torch.randn(*s, dtype=torch.bfloat16) * 0.4)(D, 3 * D)),
            "wo": _w((lambda *s: torch.randn(*s, dtype=torch.bfloat16) * 0.4)(D, D)),
        }
    _A_in = _A_setup()

    def _B_setup():
        B, S, D = 1, 2048, 512
        return {
            "x": _w((lambda *s: torch.randn(*s, dtype=torch.bfloat16) * 0.2)(B, S, D)),
            "wqkv": _w((lambda *s: torch.randn(*s, dtype=torch.bfloat16) * 0.4)(D, 3 * D)),
            "wo": _w((lambda *s: torch.randn(*s, dtype=torch.bfloat16) * 0.4)(D, D)),
        }
    _B_in = _B_setup()

    return {
        "A_x": _A_in["x"],
        "A_wqkv": _A_in["wqkv"],
        "A_wo": _A_in["wo"],
        "B_x": _B_in["x"],
        "B_wqkv": _B_in["wqkv"],
        "B_wo": _B_in["wo"],
    }

def reference(A_x, A_wqkv, A_wo, B_x, B_wqkv, B_wo):
    def _A_ref(x, wqkv, wo):
        B, S, D = x.shape
        H = 32; Dh = D // H; W = 256
        qkv = (lambda x, *d: x.permute(*d))((x @ wqkv).reshape(B, S, 3, H, Dh), 2, 0, 3, 1, 4)
        q, k, v = qkv[0], qkv[1], qkv[2]
        scores = torch.einsum("bhqd,bhkd->bhqk", q, k) * (Dh ** -0.5)
        idx = torch.arange(S)
        mask = (idx[:, None] - idx[None, :] >= 0) & (idx[:, None] - idx[None, :] < W)
        scores = torch.where(mask[None, None], scores, -1e9)
        p = _softmax(scores, axis=-1)
        o = torch.einsum("bhqk,bhkd->bhqd", p, v)
        return (lambda x, *d: x.permute(*d))(o, 0, 2, 1, 3).reshape(B, S, D) @ wo

    def _B_ref(x, wqkv, wo):
        B, S, D = x.shape
        H = 32; Dh = D // H; W = 256
        qkv = (lambda x, *d: x.permute(*d))((x @ wqkv).reshape(B, S, 3, H, Dh), 2, 0, 3, 1, 4)
        q, k, v = qkv[0], qkv[1], qkv[2]
        scores = torch.einsum("bhqd,bhkd->bhqk", q, k) * (Dh ** -0.5)
        idx = torch.arange(S)
        mask = (idx[:, None] - idx[None, :] >= 0) & (idx[:, None] - idx[None, :] < W)
        scores = torch.where(mask[None, None], scores, -1e9)
        p = _softmax(scores, axis=-1)
        o = torch.einsum("bhqk,bhkd->bhqd", p, v)
        return (lambda x, *d: x.permute(*d))(o, 0, 2, 1, 3).reshape(B, S, D) @ wo

    a = _A_ref(A_x, A_wqkv, A_wo)
    b = _B_ref(B_x, B_wqkv, B_wo)
    return torch.concatenate([a, b], axis=-1)
```

```asm
; @launch grid=(256,1,1) block=(512,1,1) lds=163840
.amdgcn_target "amdgcn-amd-amdhsa--gfx950"
.text
.globl concat_heads__sliding_block__sliding_block__prompt_kernel
.p2align 8
.type concat_heads__sliding_block__sliding_block__prompt_kernel,@function
concat_heads__sliding_block__sliding_block__prompt_kernel:
    s_cmp_ge_u32 s2, 256
    s_cbranch_scc1 L_end
    s_load_dwordx16 s[36:51], s[0:1], 0
    s_load_dwordx2 s[52:53], s[0:1], 64
    v_lshrrev_b32 v11, 6, v0
    s_and_b32 s62, s2, 7
    v_readfirstlane_b32 s27, v11
    s_lshr_b32 s63, s2, 3
    s_lshr_b32 s24, s62, 2
    s_bfe_u32 s25, s62, 0x10001
    s_lshl_b32 s25, s25, 3
    s_lshr_b32 s64, s63, 2
    s_add_u32 s25, s25, s64
    s_and_b32 s26, s62, 1
    s_lshl_b32 s26, s26, 2
    s_and_b32 s64, s63, 3
    s_add_u32 s26, s26, s64
    v_and_b32 v0, 63, v0
    s_lshr_b32 s29, s27, 2
    s_sub_u32 s64, 7, s27
    s_cmp_lt_u32 s27, 4
    s_cselect_b32 s28, s27, s64
    s_lshl_b32 s57, s27, 11
    s_lshl_b32 s58, s27, 10
    v_lshrrev_b32 v11, 3, v0
    v_and_b32 v12, 7, v0
    v_lshrrev_b32 v13, 4, v0
    v_xor_b32 v14, v12, v13
    s_lshl_b32 s64, s27, 4
    v_add_u32 v15, s64, v11
    v_lshlrev_b32 v15, 10, v15
    v_lshl_add_u32 v1, v14, 4, v15
    v_xor_b32 v14, 4, v14
    v_lshl_add_u32 v2, v14, 4, v15
    v_add_u32 v2, 8192, v2
    v_and_b32 v13, 1, v13
    v_lshlrev_b32 v13, 2, v13
    v_xor_b32 v12, v12, v13
    s_lshl_b32 s64, s27, 3
    v_add_u32 v11, s64, v11
    v_mul_u32_u24 v15, 3072, v11
    v_lshl_add_u32 v3, v12, 4, v15
    v_lshlrev_b32 v15, 10, v11
    v_lshl_add_u32 v4, v12, 4, v15
    s_lshl_b32 s34, s25, 17
    s_lshl_b32 s55, s26, 7
    s_add_u32 s35, s55, 1024
    s_mov_b32 s56, s55
    s_lshl_b32 s3, s26, 1
    s_add_u32 s3, s3, s25
    s_and_b32 s3, s3, 7
    s_waitcnt lgkmcnt(0)
    s_cmp_eq_u32 s24, 0
    s_cselect_b64 s[4:5], s[36:37], s[42:43]
    s_cselect_b64 s[8:9], s[38:39], s[44:45]
    s_cselect_b64 s[12:13], s[40:41], s[46:47]
    s_mov_b32 s6, 2097152
    s_mov_b32 s7, 0x20000
    s_mov_b32 s10, 1572864
    s_mov_b32 s11, 0x20000
    s_lshl_b32 s98, s3, 7
    s_mul_i32 s99, s3, 196608
    s_add_u32 s98, s98, s34
    s_add_u32 s99, s99, s35
    s_add_u32 m0, s57, 0
    s_nop 0
    buffer_load_dwordx4 v1, s[4:7], s98 offen lds
    s_add_u32 m0, s57, 1024
    s_nop 0
    buffer_load_dwordx4 v2, s[4:7], s98 offen lds
    s_add_u32 m0, s58, 16384
    s_nop 0
    buffer_load_dwordx4 v3, s[8:11], s99 offen lds
    s_add_u32 s99, s99, 1024
    s_add_u32 m0, s58, 24576
    s_nop 0
    buffer_load_dwordx4 v3, s[8:11], s99 offen lds
    s_add_u32 s3, s3, 1
    s_and_b32 s3, s3, 7
    s_mov_b32 s14, 524288
    s_mov_b32 s15, 0x20000
    s_mov_b64 s[16:17], s[48:49]
    s_mov_b32 s18, 4194304
    s_mov_b32 s19, 0x20000
    s_mov_b64 s[20:21], s[52:53]
    s_mov_b32 s22, 33554432
    s_mov_b32 s23, 0x20000
    s_lshl_b32 s62, s24, 5
    s_add_u32 s62, s62, s25
    s_lshl_b32 s62, s62, 2
    s_load_dword s68, s[52:53], s62
    s_add_u32 s63, s62, 4
    s_load_dword s69, s[52:53], s63
    s_add_u32 s63, s62, 8
    s_load_dword s70, s[52:53], s63
    v_and_b32 v11, 31, v0
    v_lshrrev_b32 v12, 5, v0
    v_bfe_u32 v13, v0, 1, 3
    s_lshl_b32 s64, s28, 12
    v_lshlrev_b32 v14, 7, v11
    v_add_u32 v14, s64, v14
    v_add_u32 v15, 0, v12
    v_xor_b32 v15, v15, v13
    v_lshl_add_u32 v5, v15, 4, v14
    v_add_u32 v15, 2, v12
    v_xor_b32 v15, v15, v13
    v_lshl_add_u32 v6, v15, 4, v14
    v_add_u32 v15, 4, v12
    v_xor_b32 v15, v15, v13
    v_lshl_add_u32 v7, v15, 4, v14
    v_add_u32 v15, 6, v12
    v_xor_b32 v15, v15, v13
    v_lshl_add_u32 v8, v15, 4, v14
    v_bfe_u32 v11, v0, 2, 2
    v_lshl_add_u32 v13, v12, 3, v11
    v_lshlrev_b32 v13, 7, v13
    v_bfe_u32 v14, v0, 4, 1
    v_lshlrev_b32 v14, 1, v14
    v_bfe_u32 v15, v0, 1, 1
    v_add_u32 v14, v14, v15
    s_lshl_b32 s64, s29, 2
    v_add_u32 v14, s64, v14
    v_bfe_u32 v15, v0, 3, 1
    v_lshlrev_b32 v15, 2, v15
    v_xor_b32 v14, v14, v15
    v_lshl_add_u32 v13, v14, 4, v13
    v_and_b32 v14, 1, v0
    v_lshl_add_u32 v9, v14, 3, v13
    v_lshlrev_b32 v10, 4, v0
    v_and_b32 v11, 31, v0
    v_bfe_u32 v12, v0, 5, 1
    v_lshlrev_b32 v12, 2, v12
    v_sub_u32 v11, v11, v12
    v_mov_b32 v12, 0xf149f2ca
    v_mov_b32 v13, 0
    v_cmp_le_i32 vcc, 0, v11
    s_nop 1
    v_cndmask_b32 v88, v12, v13, vcc
    v_cndmask_b32 v104, v13, v12, vcc
    v_cmp_le_i32 vcc, 1, v11
    s_nop 1
    v_cndmask_b32 v89, v12, v13, vcc
    v_cndmask_b32 v105, v13, v12, vcc
    v_cmp_le_i32 vcc, 2, v11
    s_nop 1
    v_cndmask_b32 v90, v12, v13, vcc
    v_cndmask_b32 v106, v13, v12, vcc
    v_cmp_le_i32 vcc, 3, v11
    s_nop 1
    v_cndmask_b32 v91, v12, v13, vcc
    v_cndmask_b32 v107, v13, v12, vcc
    v_cmp_le_i32 vcc, 8, v11
    s_nop 1
    v_cndmask_b32 v92, v12, v13, vcc
    v_cndmask_b32 v108, v13, v12, vcc
    v_cmp_le_i32 vcc, 9, v11
    s_nop 1
    v_cndmask_b32 v93, v12, v13, vcc
    v_cndmask_b32 v109, v13, v12, vcc
    v_cmp_le_i32 vcc, 10, v11
    s_nop 1
    v_cndmask_b32 v94, v12, v13, vcc
    v_cndmask_b32 v110, v13, v12, vcc
    v_cmp_le_i32 vcc, 11, v11
    s_nop 1
    v_cndmask_b32 v95, v12, v13, vcc
    v_cndmask_b32 v111, v13, v12, vcc
    v_cmp_le_i32 vcc, 16, v11
    s_nop 1
    v_cndmask_b32 v96, v12, v13, vcc
    v_cndmask_b32 v112, v13, v12, vcc
    v_cmp_le_i32 vcc, 17, v11
    s_nop 1
    v_cndmask_b32 v97, v12, v13, vcc
    v_cndmask_b32 v113, v13, v12, vcc
    v_cmp_le_i32 vcc, 18, v11
    s_nop 1
    v_cndmask_b32 v98, v12, v13, vcc
    v_cndmask_b32 v114, v13, v12, vcc
    v_cmp_le_i32 vcc, 19, v11
    s_nop 1
    v_cndmask_b32 v99, v12, v13, vcc
    v_cndmask_b32 v115, v13, v12, vcc
    v_cmp_le_i32 vcc, 24, v11
    s_nop 1
    v_cndmask_b32 v100, v12, v13, vcc
    v_cndmask_b32 v116, v13, v12, vcc
    v_cmp_le_i32 vcc, 25, v11
    s_nop 1
    v_cndmask_b32 v101, v12, v13, vcc
    v_cndmask_b32 v117, v13, v12, vcc
    v_cmp_le_i32 vcc, 26, v11
    s_nop 1
    v_cndmask_b32 v102, v12, v13, vcc
    v_cndmask_b32 v118, v13, v12, vcc
    v_cmp_le_i32 vcc, 27, v11
    s_nop 1
    v_cndmask_b32 v103, v12, v13, vcc
    v_cndmask_b32 v119, v13, v12, vcc
    s_mov_b32 s72, 0x0000ffff
    s_mov_b32 s73, 0x0000ffff
    s_lshl_b32 s62, s24, 3
    s_add_u32 s62, s62, s26
    s_lshl_b32 s62, s62, 4
    s_add_u32 s45, s62, s25
    s_lshl_b32 s46, s45, 3
    s_add_u32 s46, s46, 4096
    s_lshl_b32 s62, s45, 15
    s_add_u32 s62, s62, 2097152
    v_mov_b32 v11, s62
    s_lshl_b32 s62, s24, 4
    s_add_u32 s62, s62, s25
    s_lshl_b32 s62, s62, 2
    s_add_u32 s62, s62, s28
    s_lshl_b32 s63, s62, 15
    s_add_u32 s63, s63, 16777216
    v_writelane_b32 v11, s63, 1
    s_and_b32 s64, s62, 63
    s_lshl_b32 s64, s64, 16
    s_lshl_b32 s62, s62, 1
    s_add_u32 s62, s62, s29
    s_lshl_b32 s62, s62, 8
    s_add_u32 s62, s62, 65536
    v_writelane_b32 v11, s62, 2
    s_add_u32 s62, s62, 128
    v_writelane_b32 v11, s62, 3
    s_lshl_b32 s62, s45, 2
    s_add_u32 s62, s62, s27
    s_lshl_b32 s62, s62, 8
    s_add_u32 s62, s62, 260096
    v_writelane_b32 v11, s62, 4
    s_add_u32 s62, s62, 128
    v_writelane_b32 v11, s62, 5
    s_mov_b64 exec, 0x3f
    buffer_load_dword v254, v11, s[20:23], 0 offen sc1
    s_mov_b64 exec, 1
    buffer_load_dword v253, off, s[16:19], s64
    buffer_load_dword v252, off, s[12:15], s56
    s_mov_b64 exec, -1
    s_lshl_b32 s98, s3, 7
    s_mul_i32 s99, s3, 196608
    s_add_u32 s98, s98, s34
    s_add_u32 s99, s99, s35
    s_add_u32 m0, s57, 32768
    s_nop 0
    buffer_load_dwordx4 v1, s[4:7], s98 offen lds
    s_add_u32 m0, s57, 33792
    s_nop 0
    buffer_load_dwordx4 v2, s[4:7], s98 offen lds
    s_add_u32 m0, s58, 49152
    s_nop 0
    buffer_load_dwordx4 v3, s[8:11], s99 offen lds
    s_add_u32 s99, s99, 1024
    s_add_u32 m0, s58, 57344
    s_nop 0
    buffer_load_dwordx4 v3, s[8:11], s99 offen lds
    s_add_u32 s3, s3, 1
    s_and_b32 s3, s3, 7
    s_waitcnt vmcnt(4)
    s_barrier
    ds_read_b128 v[128:131], v5
    ds_read_b64_tr_b16 v[64:65], v9 offset:16384
    ds_read_b64_tr_b16 v[66:67], v9 offset:16896
    ds_read_b64_tr_b16 v[68:69], v9 offset:24576
    ds_read_b64_tr_b16 v[70:71], v9 offset:25088
    ds_read_b128 v[132:135], v6
    ds_read_b64_tr_b16 v[72:73], v9 offset:18432
    ds_read_b64_tr_b16 v[74:75], v9 offset:18944
    ds_read_b64_tr_b16 v[76:77], v9 offset:26624
    ds_read_b64_tr_b16 v[78:79], v9 offset:27136
    ds_read_b128 v[136:139], v7
    ds_read_b64_tr_b16 v[80:81], v9 offset:20480
    ds_read_b64_tr_b16 v[82:83], v9 offset:20992
    ds_read_b64_tr_b16 v[84:85], v9 offset:28672
    ds_read_b64_tr_b16 v[86:87], v9 offset:29184
    s_waitcnt lgkmcnt(10)
    v_mfma_f32_32x32x16_bf16 v[16:31], v[64:67], v[128:131], 0
    v_mfma_f32_32x32x16_bf16 v[32:47], v[128:131], v[68:71], 0
    s_lshl_b32 s98, s3, 7
    s_mul_i32 s99, s3, 196608
    s_add_u32 s98, s98, s34
    s_add_u32 s99, s99, s35
    s_add_u32 m0, s57, 65536
    s_nop 0
    buffer_load_dwordx4 v1, s[4:7], s98 offen lds
    s_add_u32 m0, s57, 66560
    s_nop 0
    buffer_load_dwordx4 v2, s[4:7], s98 offen lds
    ds_read_b128 v[140:143], v8
    ds_read_b64_tr_b16 v[64:65], v9 offset:22528
    ds_read_b64_tr_b16 v[66:67], v9 offset:23040
    ds_read_b64_tr_b16 v[68:69], v9 offset:30720
    ds_read_b64_tr_b16 v[70:71], v9 offset:31232
    s_waitcnt lgkmcnt(10)
    v_mfma_f32_32x32x16_bf16 v[16:31], v[72:75], v[132:135], v[16:31]
    v_mfma_f32_32x32x16_bf16 v[32:47], v[132:135], v[76:79], v[32:47]
    s_add_u32 m0, s58, 81920
    s_nop 0
    buffer_load_dwordx4 v3, s[8:11], s99 offen lds
    s_add_u32 s99, s99, 1024
    s_add_u32 m0, s58, 90112
    s_nop 0
    buffer_load_dwordx4 v3, s[8:11], s99 offen lds
    s_add_u32 s3, s3, 1
    s_and_b32 s3, s3, 7
    s_waitcnt vmcnt(4)
    s_barrier
    v_add_u32 v5, 32768, v5
    v_add_u32 v6, 32768, v6
    v_add_u32 v7, 32768, v7
    v_add_u32 v8, 32768, v8
    v_add_u32 v9, 32768, v9
    ds_read_b128 v[144:147], v5
    ds_read_b64_tr_b16 v[72:73], v9 offset:16384
    ds_read_b64_tr_b16 v[74:75], v9 offset:16896
    ds_read_b64_tr_b16 v[76:77], v9 offset:24576
    ds_read_b64_tr_b16 v[78:79], v9 offset:25088
    s_waitcnt lgkmcnt(10)
    v_mfma_f32_32x32x16_bf16 v[16:31], v[80:83], v[136:139], v[16:31]
    v_mfma_f32_32x32x16_bf16 v[32:47], v[136:139], v[84:87], v[32:47]
    s_lshl_b32 s98, s3, 7
    s_mul_i32 s99, s3, 196608
    s_add_u32 s98, s98, s34
    s_add_u32 s99, s99, s35
    s_add_u32 m0, s57, 98304
    s_nop 0
    buffer_load_dwordx4 v1, s[4:7], s98 offen lds
    ds_read_b128 v[148:151], v6
    ds_read_b64_tr_b16 v[80:81], v9 offset:18432
    ds_read_b64_tr_b16 v[82:83], v9 offset:18944
    ds_read_b64_tr_b16 v[84:85], v9 offset:26624
    ds_read_b64_tr_b16 v[86:87], v9 offset:27136
    s_waitcnt lgkmcnt(10)
    v_mfma_f32_32x32x16_bf16 v[16:31], v[64:67], v[140:143], v[16:31]
    v_mfma_f32_32x32x16_bf16 v[32:47], v[140:143], v[68:71], v[32:47]
    s_add_u32 m0, s57, 99328
    s_nop 0
    buffer_load_dwordx4 v2, s[4:7], s98 offen lds
    ds_read_b128 v[152:155], v7
    ds_read_b64_tr_b16 v[64:65], v9 offset:20480
    ds_read_b64_tr_b16 v[66:67], v9 offset:20992
    ds_read_b64_tr_b16 v[68:69], v9 offset:28672
    ds_read_b64_tr_b16 v[70:71], v9 offset:29184
    s_waitcnt lgkmcnt(10)
    v_mfma_f32_32x32x16_bf16 v[16:31], v[72:75], v[144:147], v[16:31]
    v_mfma_f32_32x32x16_bf16 v[32:47], v[144:147], v[76:79], v[32:47]
    s_add_u32 m0, s58, 114688
    s_nop 0
    buffer_load_dwordx4 v3, s[8:11], s99 offen lds
    ds_read_b128 v[156:159], v8
    ds_read_b64_tr_b16 v[72:73], v9 offset:22528
    ds_read_b64_tr_b16 v[74:75], v9 offset:23040
    ds_read_b64_tr_b16 v[76:77], v9 offset:30720
    ds_read_b64_tr_b16 v[78:79], v9 offset:31232
    s_waitcnt lgkmcnt(10)
    v_mfma_f32_32x32x16_bf16 v[16:31], v[80:83], v[148:151], v[16:31]
    v_mfma_f32_32x32x16_bf16 v[32:47], v[148:151], v[84:87], v[32:47]
    s_add_u32 s99, s99, 1024
    s_add_u32 m0, s58, 122880
    s_nop 0
    buffer_load_dwordx4 v3, s[8:11], s99 offen lds
    s_add_u32 s3, s3, 1
    s_and_b32 s3, s3, 7
    s_waitcnt vmcnt(4)
    s_barrier
    v_add_u32 v5, 32768, v5
    v_add_u32 v6, 32768, v6
    v_add_u32 v7, 32768, v7
    v_add_u32 v8, 32768, v8
    v_add_u32 v9, 32768, v9
    ds_read_b128 v[160:163], v5
    ds_read_b64_tr_b16 v[80:81], v9 offset:16384
    ds_read_b64_tr_b16 v[82:83], v9 offset:16896
    ds_read_b64_tr_b16 v[84:85], v9 offset:24576
    ds_read_b64_tr_b16 v[86:87], v9 offset:25088
    s_waitcnt lgkmcnt(10)
    v_mfma_f32_32x32x16_bf16 v[16:31], v[64:67], v[152:155], v[16:31]
    v_mfma_f32_32x32x16_bf16 v[32:47], v[152:155], v[68:71], v[32:47]
    s_lshl_b32 s98, s3, 7
    s_mul_i32 s99, s3, 196608
    s_add_u32 s98, s98, s34
    s_add_u32 s99, s99, s35
    s_add_u32 m0, s57, 131072
    s_nop 0
    buffer_load_dwordx4 v1, s[4:7], s98 offen lds
    ds_read_b128 v[164:167], v6
    ds_read_b64_tr_b16 v[64:65], v9 offset:18432
    ds_read_b64_tr_b16 v[66:67], v9 offset:18944
    ds_read_b64_tr_b16 v[68:69], v9 offset:26624
    ds_read_b64_tr_b16 v[70:71], v9 offset:27136
    s_waitcnt lgkmcnt(10)
    v_mfma_f32_32x32x16_bf16 v[16:31], v[72:75], v[156:159], v[16:31]
    v_mfma_f32_32x32x16_bf16 v[32:47], v[156:159], v[76:79], v[32:47]
    s_add_u32 m0, s57, 132096
    s_nop 0
    buffer_load_dwordx4 v2, s[4:7], s98 offen lds
    ds_read_b128 v[168:171], v7
    ds_read_b64_tr_b16 v[72:73], v9 offset:20480
    ds_read_b64_tr_b16 v[74:75], v9 offset:20992
    ds_read_b64_tr_b16 v[76:77], v9 offset:28672
    ds_read_b64_tr_b16 v[78:79], v9 offset:29184
    s_waitcnt lgkmcnt(10)
    v_mfma_f32_32x32x16_bf16 v[16:31], v[80:83], v[160:163], v[16:31]
    v_mfma_f32_32x32x16_bf16 v[32:47], v[160:163], v[84:87], v[32:47]
    s_add_u32 m0, s58, 147456
    s_nop 0
    buffer_load_dwordx4 v3, s[8:11], s99 offen lds
    ds_read_b128 v[172:175], v8
    ds_read_b64_tr_b16 v[80:81], v9 offset:22528
    ds_read_b64_tr_b16 v[82:83], v9 offset:23040
    ds_read_b64_tr_b16 v[84:85], v9 offset:30720
    ds_read_b64_tr_b16 v[86:87], v9 offset:31232
    s_waitcnt lgkmcnt(10)
    v_mfma_f32_32x32x16_bf16 v[16:31], v[64:67], v[164:167], v[16:31]
    v_mfma_f32_32x32x16_bf16 v[32:47], v[164:167], v[68:71], v[32:47]
    s_add_u32 s99, s99, 1024
    s_add_u32 m0, s58, 155648
    s_nop 0
    buffer_load_dwordx4 v3, s[8:11], s99 offen lds
    s_add_u32 s3, s3, 1
    s_and_b32 s3, s3, 7
    s_waitcnt vmcnt(4)
    s_barrier
    v_add_u32 v5, 32768, v5
    v_add_u32 v6, 32768, v6
    v_add_u32 v7, 32768, v7
    v_add_u32 v8, 32768, v8
    v_add_u32 v9, 32768, v9
    ds_read_b128 v[176:179], v5
    ds_read_b64_tr_b16 v[64:65], v9 offset:16384
    ds_read_b64_tr_b16 v[66:67], v9 offset:16896
    ds_read_b64_tr_b16 v[68:69], v9 offset:24576
    ds_read_b64_tr_b16 v[70:71], v9 offset:25088
    s_waitcnt lgkmcnt(10)
    v_mfma_f32_32x32x16_bf16 v[16:31], v[72:75], v[168:171], v[16:31]
    v_mfma_f32_32x32x16_bf16 v[32:47], v[168:171], v[76:79], v[32:47]
    s_lshl_b32 s98, s3, 7
    s_mul_i32 s99, s3, 196608
    s_add_u32 s98, s98, s34
    s_add_u32 s99, s99, s35
    s_add_u32 m0, s57, 0
    s_nop 0
    buffer_load_dwordx4 v1, s[4:7], s98 offen lds
    ds_read_b128 v[180:183], v6
    ds_read_b64_tr_b16 v[72:73], v9 offset:18432
    ds_read_b64_tr_b16 v[74:75], v9 offset:18944
    ds_read_b64_tr_b16 v[76:77], v9 offset:26624
    ds_read_b64_tr_b16 v[78:79], v9 offset:27136
    s_waitcnt lgkmcnt(10)
    v_mfma_f32_32x32x16_bf16 v[16:31], v[80:83], v[172:175], v[16:31]
    v_mfma_f32_32x32x16_bf16 v[32:47], v[172:175], v[84:87], v[32:47]
    s_add_u32 m0, s57, 1024
    s_nop 0
    buffer_load_dwordx4 v2, s[4:7], s98 offen lds
    ds_read_b128 v[184:187], v7
    ds_read_b64_tr_b16 v[80:81], v9 offset:20480
    ds_read_b64_tr_b16 v[82:83], v9 offset:20992
    ds_read_b64_tr_b16 v[84:85], v9 offset:28672
    ds_read_b64_tr_b16 v[86:87], v9 offset:29184
    s_waitcnt lgkmcnt(10)
    v_mfma_f32_32x32x16_bf16 v[16:31], v[64:67], v[176:179], v[16:31]
    v_mfma_f32_32x32x16_bf16 v[32:47], v[176:179], v[68:71], v[32:47]
    s_add_u32 m0, s58, 16384
    s_nop 0
    buffer_load_dwordx4 v3, s[8:11], s99 offen lds
    ds_read_b128 v[188:191], v8
    ds_read_b64_tr_b16 v[64:65], v9 offset:22528
    ds_read_b64_tr_b16 v[66:67], v9 offset:23040
    ds_read_b64_tr_b16 v[68:69], v9 offset:30720
    ds_read_b64_tr_b16 v[70:71], v9 offset:31232
    s_waitcnt lgkmcnt(10)
    v_mfma_f32_32x32x16_bf16 v[16:31], v[72:75], v[180:183], v[16:31]
    v_mfma_f32_32x32x16_bf16 v[32:47], v[180:183], v[76:79], v[32:47]
    s_add_u32 s99, s99, 1024
    s_add_u32 m0, s58, 24576
    s_nop 0
    buffer_load_dwordx4 v3, s[8:11], s99 offen lds
    s_add_u32 s3, s3, 1
    s_and_b32 s3, s3, 7
    s_waitcnt vmcnt(4)
    s_barrier
    v_add_u32 v5, 32768, v5
    v_add_u32 v6, 32768, v6
    v_add_u32 v7, 32768, v7
    v_add_u32 v8, 32768, v8
    v_add_u32 v9, 32768, v9
    ds_read_b128 v[192:195], v5
    ds_read_b64_tr_b16 v[72:73], v9 offset:16384
    ds_read_b64_tr_b16 v[74:75], v9 offset:16896
    ds_read_b64_tr_b16 v[76:77], v9 offset:24576
    ds_read_b64_tr_b16 v[78:79], v9 offset:25088
    s_waitcnt lgkmcnt(10)
    v_mfma_f32_32x32x16_bf16 v[16:31], v[80:83], v[184:187], v[16:31]
    v_mfma_f32_32x32x16_bf16 v[32:47], v[184:187], v[84:87], v[32:47]
    s_lshl_b32 s98, s3, 7
    s_mul_i32 s99, s3, 196608
    s_add_u32 s98, s98, s34
    s_add_u32 s99, s99, s35
    s_add_u32 m0, s57, 32768
    s_nop 0
    buffer_load_dwordx4 v1, s[4:7], s98 offen lds
    ds_read_b128 v[196:199], v6
    ds_read_b64_tr_b16 v[80:81], v9 offset:18432
    ds_read_b64_tr_b16 v[82:83], v9 offset:18944
    ds_read_b64_tr_b16 v[84:85], v9 offset:26624
    ds_read_b64_tr_b16 v[86:87], v9 offset:27136
    s_waitcnt lgkmcnt(10)
    v_mfma_f32_32x32x16_bf16 v[16:31], v[64:67], v[188:191], v[16:31]
    v_mfma_f32_32x32x16_bf16 v[32:47], v[188:191], v[68:71], v[32:47]
    s_add_u32 m0, s57, 33792
    s_nop 0
    buffer_load_dwordx4 v2, s[4:7], s98 offen lds
    ds_read_b128 v[200:203], v7
    ds_read_b64_tr_b16 v[64:65], v9 offset:20480
    ds_read_b64_tr_b16 v[66:67], v9 offset:20992
    ds_read_b64_tr_b16 v[68:69], v9 offset:28672
    ds_read_b64_tr_b16 v[70:71], v9 offset:29184
    s_waitcnt lgkmcnt(10)
    v_mfma_f32_32x32x16_bf16 v[16:31], v[72:75], v[192:195], v[16:31]
    v_mfma_f32_32x32x16_bf16 v[32:47], v[192:195], v[76:79], v[32:47]
    s_add_u32 m0, s58, 49152
    s_nop 0
    buffer_load_dwordx4 v3, s[8:11], s99 offen lds
    ds_read_b128 v[204:207], v8
    ds_read_b64_tr_b16 v[72:73], v9 offset:22528
    ds_read_b64_tr_b16 v[74:75], v9 offset:23040
    ds_read_b64_tr_b16 v[76:77], v9 offset:30720
    ds_read_b64_tr_b16 v[78:79], v9 offset:31232
    s_waitcnt lgkmcnt(10)
    v_mfma_f32_32x32x16_bf16 v[16:31], v[80:83], v[196:199], v[16:31]
    v_mfma_f32_32x32x16_bf16 v[32:47], v[196:199], v[84:87], v[32:47]
    s_add_u32 s99, s99, 1024
    s_add_u32 m0, s58, 57344
    s_nop 0
    buffer_load_dwordx4 v3, s[8:11], s99 offen lds
    s_add_u32 s3, s3, 1
    s_and_b32 s3, s3, 7
    s_waitcnt vmcnt(4)
    s_barrier
    v_add_u32 v5, 4294836224, v5
    v_add_u32 v6, 4294836224, v6
    v_add_u32 v7, 4294836224, v7
    v_add_u32 v8, 4294836224, v8
    v_add_u32 v9, 4294836224, v9
    ds_read_b128 v[208:211], v5
    ds_read_b64_tr_b16 v[80:81], v9 offset:16384
    ds_read_b64_tr_b16 v[82:83], v9 offset:16896
    ds_read_b64_tr_b16 v[84:85], v9 offset:24576
    ds_read_b64_tr_b16 v[86:87], v9 offset:25088
    s_waitcnt lgkmcnt(10)
    v_mfma_f32_32x32x16_bf16 v[16:31], v[64:67], v[200:203], v[16:31]
    v_mfma_f32_32x32x16_bf16 v[32:47], v[200:203], v[68:71], v[32:47]
    s_lshl_b32 s98, s3, 7
    s_mul_i32 s99, s3, 196608
    s_add_u32 s98, s98, s34
    s_add_u32 s99, s99, s35
    s_add_u32 m0, s57, 65536
    s_nop 0
    buffer_load_dwordx4 v1, s[4:7], s98 offen lds
    ds_read_b128 v[212:215], v6
    ds_read_b64_tr_b16 v[64:65], v9 offset:18432
    ds_read_b64_tr_b16 v[66:67], v9 offset:18944
    ds_read_b64_tr_b16 v[68:69], v9 offset:26624
    ds_read_b64_tr_b16 v[70:71], v9 offset:27136
    s_waitcnt lgkmcnt(10)
    v_mfma_f32_32x32x16_bf16 v[16:31], v[72:75], v[204:207], v[16:31]
    v_mfma_f32_32x32x16_bf16 v[32:47], v[204:207], v[76:79], v[32:47]
    s_add_u32 m0, s57, 66560
    s_nop 0
    buffer_load_dwordx4 v2, s[4:7], s98 offen lds
    ds_read_b128 v[216:219], v7
    ds_read_b64_tr_b16 v[72:73], v9 offset:20480
    ds_read_b64_tr_b16 v[74:75], v9 offset:20992
    ds_read_b64_tr_b16 v[76:77], v9 offset:28672
    ds_read_b64_tr_b16 v[78:79], v9 offset:29184
    s_waitcnt lgkmcnt(10)
    v_mfma_f32_32x32x16_bf16 v[16:31], v[80:83], v[208:211], v[16:31]
    v_mfma_f32_32x32x16_bf16 v[32:47], v[208:211], v[84:87], v[32:47]
    s_add_u32 m0, s58, 81920
    s_nop 0
    buffer_load_dwordx4 v3, s[8:11], s99 offen lds
    ds_read_b128 v[220:223], v8
    ds_read_b64_tr_b16 v[80:81], v9 offset:22528
    ds_read_b64_tr_b16 v[82:83], v9 offset:23040
    ds_read_b64_tr_b16 v[84:85], v9 offset:30720
    ds_read_b64_tr_b16 v[86:87], v9 offset:31232
    s_waitcnt lgkmcnt(10)
    v_mfma_f32_32x32x16_bf16 v[16:31], v[64:67], v[212:215], v[16:31]
    v_mfma_f32_32x32x16_bf16 v[32:47], v[212:215], v[68:71], v[32:47]
    s_add_u32 s99, s99, 1024
    s_add_u32 m0, s58, 90112
    s_nop 0
    buffer_load_dwordx4 v3, s[8:11], s99 offen lds
    s_add_u32 s3, s3, 1
    s_and_b32 s3, s3, 7
    s_waitcnt vmcnt(4)
    s_barrier
    v_add_u32 v5, 32768, v5
    v_add_u32 v6, 32768, v6
    v_add_u32 v7, 32768, v7
    v_add_u32 v8, 32768, v8
    v_add_u32 v9, 32768, v9
    ds_read_b128 v[224:227], v5
    ds_read_b64_tr_b16 v[64:65], v9 offset:16384
    ds_read_b64_tr_b16 v[66:67], v9 offset:16896
    ds_read_b64_tr_b16 v[68:69], v9 offset:24576
    ds_read_b64_tr_b16 v[70:71], v9 offset:25088
    s_waitcnt lgkmcnt(10)
    v_mfma_f32_32x32x16_bf16 v[16:31], v[72:75], v[216:219], v[16:31]
    v_mfma_f32_32x32x16_bf16 v[32:47], v[216:219], v[76:79], v[32:47]
    s_mul_i32 s99, s3, 196608
    s_add_u32 s99, s99, s55
    s_add_u32 m0, s58, 98304
    s_nop 0
    buffer_load_dwordx4 v3, s[8:11], s99 offen lds
    s_add_u32 s3, s3, 1
    s_and_b32 s3, s3, 7
    ds_read_b128 v[228:231], v6
    ds_read_b64_tr_b16 v[72:73], v9 offset:18432
    ds_read_b64_tr_b16 v[74:75], v9 offset:18944
    ds_read_b64_tr_b16 v[76:77], v9 offset:26624
    ds_read_b64_tr_b16 v[78:79], v9 offset:27136
    s_waitcnt lgkmcnt(10)
    v_mfma_f32_32x32x16_bf16 v[16:31], v[80:83], v[220:223], v[16:31]
    v_mfma_f32_32x32x16_bf16 v[32:47], v[220:223], v[84:87], v[32:47]
    s_mul_i32 s99, s3, 196608
    s_add_u32 s99, s99, s55
    s_add_u32 m0, s58, 106496
    s_nop 0
    buffer_load_dwordx4 v3, s[8:11], s99 offen lds
    s_add_u32 s3, s3, 1
    s_and_b32 s3, s3, 7
    ds_read_b128 v[232:235], v7
    ds_read_b64_tr_b16 v[80:81], v9 offset:20480
    ds_read_b64_tr_b16 v[82:83], v9 offset:20992
    ds_read_b64_tr_b16 v[84:85], v9 offset:28672
    ds_read_b64_tr_b16 v[86:87], v9 offset:29184
    s_waitcnt lgkmcnt(10)
    v_mfma_f32_32x32x16_bf16 v[16:31], v[64:67], v[224:227], v[16:31]
    v_mfma_f32_32x32x16_bf16 v[32:47], v[224:227], v[68:71], v[32:47]
    s_mul_i32 s99, s3, 196608
    s_add_u32 s99, s99, s55
    s_add_u32 m0, s58, 114688
    s_nop 0
    buffer_load_dwordx4 v3, s[8:11], s99 offen lds
    s_add_u32 s3, s3, 1
    s_and_b32 s3, s3, 7
    ds_read_b128 v[236:239], v8
    ds_read_b64_tr_b16 v[64:65], v9 offset:22528
    ds_read_b64_tr_b16 v[66:67], v9 offset:23040
    ds_read_b64_tr_b16 v[68:69], v9 offset:30720
    ds_read_b64_tr_b16 v[70:71], v9 offset:31232
    s_waitcnt lgkmcnt(10)
    v_mfma_f32_32x32x16_bf16 v[16:31], v[72:75], v[228:231], v[16:31]
    v_mfma_f32_32x32x16_bf16 v[32:47], v[228:231], v[76:79], v[32:47]
    s_mul_i32 s99, s3, 196608
    s_add_u32 s99, s99, s55
    s_add_u32 m0, s58, 122880
    s_nop 0
    buffer_load_dwordx4 v3, s[8:11], s99 offen lds
    s_add_u32 s3, s3, 1
    s_and_b32 s3, s3, 7
    s_waitcnt vmcnt(4)
    s_barrier
    v_add_u32 v5, 32768, v5
    v_add_u32 v6, 32768, v6
    v_add_u32 v7, 32768, v7
    v_add_u32 v8, 32768, v8
    v_add_u32 v9, 32768, v9
    ds_read_b128 v[240:243], v5
    ds_read_b64_tr_b16 v[72:73], v9 offset:16384
    ds_read_b64_tr_b16 v[74:75], v9 offset:16896
    ds_read_b64_tr_b16 v[76:77], v9 offset:24576
    ds_read_b64_tr_b16 v[78:79], v9 offset:25088
    s_waitcnt lgkmcnt(10)
    v_mfma_f32_32x32x16_bf16 v[16:31], v[80:83], v[232:235], v[16:31]
    v_mfma_f32_32x32x16_bf16 v[32:47], v[232:235], v[84:87], v[32:47]
    s_mul_i32 s99, s3, 196608
    s_add_u32 s99, s99, s55
    s_add_u32 m0, s58, 131072
    s_nop 0
    buffer_load_dwordx4 v3, s[8:11], s99 offen lds
    s_add_u32 s3, s3, 1
    s_and_b32 s3, s3, 7
    ds_read_b128 v[244:247], v6
    ds_read_b64_tr_b16 v[80:81], v9 offset:18432
    ds_read_b64_tr_b16 v[82:83], v9 offset:18944
    ds_read_b64_tr_b16 v[84:85], v9 offset:26624
    ds_read_b64_tr_b16 v[86:87], v9 offset:27136
    s_waitcnt lgkmcnt(10)
    v_mfma_f32_32x32x16_bf16 v[16:31], v[64:67], v[236:239], v[16:31]
    v_mfma_f32_32x32x16_bf16 v[32:47], v[236:239], v[68:71], v[32:47]
    s_mul_i32 s99, s3, 196608
    s_add_u32 s99, s99, s55
    s_add_u32 m0, s58, 139264
    s_nop 0
    buffer_load_dwordx4 v3, s[8:11], s99 offen lds
    s_add_u32 s3, s3, 1
    s_and_b32 s3, s3, 7
    ds_read_b128 v[248:251], v7
    ds_read_b64_tr_b16 v[64:65], v9 offset:20480
    ds_read_b64_tr_b16 v[66:67], v9 offset:20992
    ds_read_b64_tr_b16 v[68:69], v9 offset:28672
    ds_read_b64_tr_b16 v[70:71], v9 offset:29184
    s_waitcnt lgkmcnt(10)
    v_mfma_f32_32x32x16_bf16 v[16:31], v[72:75], v[240:243], v[16:31]
    v_mfma_f32_32x32x16_bf16 v[32:47], v[240:243], v[76:79], v[32:47]
    s_mul_i32 s99, s3, 196608
    s_add_u32 s99, s99, s55
    s_add_u32 m0, s58, 147456
    s_nop 0
    buffer_load_dwordx4 v3, s[8:11], s99 offen lds
    s_add_u32 s3, s3, 1
    s_and_b32 s3, s3, 7
    s_lshl_b32 s77, s45, 10
    s_lshl_b32 s63, s28, 8
    s_add_u32 s77, s77, s63
    s_lshl_b32 s63, s29, 7
    s_add_u32 s77, s77, s63
    s_add_u32 s77, s77, 262144
    s_lshl_b32 s74, s45, 15
    s_lshl_b32 s63, s28, 13
    s_add_u32 s74, s74, s63
    s_lshl_b32 s64, s29, 11
    s_add_u32 s74, s74, s64
    s_add_u32 s74, s74, 2097152
    v_and_b32 v2, 31, v0
    v_lshlrev_b32 v2, 6, v2
    v_lshrrev_b32 v1, 5, v0
    v_lshl_add_u32 v2, v1, 12, v2
    ds_read_b128 v[252:255], v8
    ds_read_b64_tr_b16 v[72:73], v9 offset:22528
    ds_read_b64_tr_b16 v[74:75], v9 offset:23040
    ds_read_b64_tr_b16 v[76:77], v9 offset:30720
    ds_read_b64_tr_b16 v[78:79], v9 offset:31232
    s_waitcnt lgkmcnt(10)
    v_mfma_f32_32x32x16_bf16 v[16:31], v[80:83], v[244:247], v[16:31]
    v_mfma_f32_32x32x16_bf16 v[32:47], v[244:247], v[84:87], v[32:47]
    s_mul_i32 s99, s3, 196608
    s_add_u32 s99, s99, s55
    s_add_u32 m0, s58, 155648
    s_nop 0
    buffer_load_dwordx4 v3, s[8:11], s99 offen lds
    s_add_u32 s3, s3, 1
    s_and_b32 s3, s3, 7
    s_waitcnt lgkmcnt(5)
    v_mfma_f32_32x32x16_bf16 v[16:31], v[64:67], v[248:251], v[16:31]
    v_mfma_f32_32x32x16_bf16 v[32:47], v[248:251], v[68:71], v[32:47]
    s_waitcnt lgkmcnt(0)
    v_mfma_f32_32x32x16_bf16 v[16:31], v[72:75], v[252:255], v[16:31]
    v_mfma_f32_32x32x16_bf16 v[32:47], v[252:255], v[76:79], v[32:47]
    s_waitcnt vmcnt(4)
    s_barrier
    s_mul_i32 s30, s70, 1664525
    s_add_u32 s30, s30, 1013904223
    s_xor_b32 s31, s30, 0x9e3779b9
    s_cmp_lt_u32 s27, 4
    s_cselect_b32 s62, s68, s69
    s_mul_i32 s32, s62, 1664525
    s_add_u32 s32, s32, 1013904223
    s_xor_b32 s33, s32, 0x9e3779b9
    v_add_u32 v9, 32768, v9
    ds_read_b64_tr_b16 v[64:65], v9 offset:0
    ds_read_b64_tr_b16 v[66:67], v9 offset:512
    ds_read_b64_tr_b16 v[68:69], v9 offset:2048
    ds_read_b64_tr_b16 v[70:71], v9 offset:2560
    ds_read_b64_tr_b16 v[72:73], v9 offset:4096
    ds_read_b64_tr_b16 v[74:75], v9 offset:4608
    ds_read_b64_tr_b16 v[76:77], v9 offset:6144
    ds_read_b64_tr_b16 v[78:79], v9 offset:6656
    s_lshl_b32 s63, s28, 13
    s_lshl_b32 s64, s29, 11
    v_and_b32 v11, 15, v0
    v_lshlrev_b32 v11, 4, v11
    v_bfe_u32 v12, v0, 4, 1
    v_lshl_add_u32 v11, v12, 10, v11
    v_lshrrev_b32 v12, 5, v0
    v_lshl_add_u32 v11, v12, 8, v11
    v_add_u32 v11, 4096, v11
    s_sub_u32 s65, 90112, s63
    s_add_u32 s65, s65, s64
    v_add_u32 v12, s65, v10
    v_add_u32 v13, s65, v11
    v_cvt_pk_bf16_f32 v120, v16, v17
    v_cvt_pk_bf16_f32 v121, v18, v19
    v_cvt_pk_bf16_f32 v122, v20, v21
    v_cvt_pk_bf16_f32 v123, v22, v23
    v_cvt_pk_bf16_f32 v124, v24, v25
    v_cvt_pk_bf16_f32 v125, v26, v27
    v_cvt_pk_bf16_f32 v126, v28, v29
    v_cvt_pk_bf16_f32 v127, v30, v31
    v_cvt_pk_bf16_f32 v16, v32, v33
    v_cvt_pk_bf16_f32 v17, v34, v35
    v_cvt_pk_bf16_f32 v18, v36, v37
    v_cvt_pk_bf16_f32 v19, v38, v39
    v_cvt_pk_bf16_f32 v20, v40, v41
    v_cvt_pk_bf16_f32 v21, v42, v43
    v_cvt_pk_bf16_f32 v22, v44, v45
    v_cvt_pk_bf16_f32 v23, v46, v47
    buffer_store_dwordx4 v[120:123], v10, s[20:23], s74 offen sc1
    buffer_store_dwordx4 v[124:127], v10, s[20:23], s74 offen offset:1024 sc1
    buffer_store_dwordx4 v[16:19], v11, s[20:23], s74 offen sc1
    buffer_store_dwordx4 v[20:23], v11, s[20:23], s74 offen offset:512 sc1
    s_lshl_b32 s98, s24, 4
    s_add_u32 s98, s98, s25
    s_lshl_b32 s98, s98, 2
    s_add_u32 s98, s98, s28
    s_lshl_b32 s98, s98, 3
    s_add_u32 s98, s98, s26
    s_lshl_b32 s98, s98, 1
    s_add_u32 s98, s98, s29
    s_lshl_b32 s98, s98, 11
    s_add_u32 s98, s98, 16778240
    v_mov_b32 v40, -1
    v_mov_b32 v41, -1
    v_mov_b32 v42, -1
    v_mov_b32 v43, -1
    buffer_store_dwordx4 v[40:43], v10, s[20:23], s98 offen sc1
    ds_read_b64_tr_b16 v[80:81], v9 offset:8192
    ds_read_b64_tr_b16 v[82:83], v9 offset:8704
    s_waitcnt lgkmcnt(8)
    v_mfma_f32_32x32x16_bf16 v[48:63], v[64:67], v[128:131], 0
    ds_write_b128 v12, v[120:123]
    ds_write_b128 v12, v[124:127] offset:1024
    ds_write_b128 v13, v[16:19]
    ds_write_b128 v13, v[20:23] offset:512
    ds_read_b64_tr_b16 v[84:85], v9 offset:10240
    ds_read_b64_tr_b16 v[86:87], v9 offset:10752
    s_waitcnt lgkmcnt(12)
    v_mfma_f32_32x32x16_bf16 v[48:63], v[68:71], v[132:135], v[48:63]
    ds_read_b64_tr_b16 v[64:65], v9 offset:12288
    ds_read_b64_tr_b16 v[66:67], v9 offset:12800
    s_waitcnt lgkmcnt(12)
    v_mfma_f32_32x32x16_bf16 v[48:63], v[72:75], v[136:139], v[48:63]
    ds_read_b64_tr_b16 v[68:69], v9 offset:14336
    ds_read_b64_tr_b16 v[70:71], v9 offset:14848
    s_waitcnt lgkmcnt(12)
    v_mfma_f32_32x32x16_bf16 v[48:63], v[76:79], v[140:143], v[48:63]
    ds_read_b64_tr_b16 v[72:73], v9 offset:16384
    ds_read_b64_tr_b16 v[74:75], v9 offset:16896
    s_waitcnt lgkmcnt(12)
    v_mfma_f32_32x32x16_bf16 v[48:63], v[80:83], v[144:147], v[48:63]
    ds_read_b64_tr_b16 v[76:77], v9 offset:18432
    ds_read_b64_tr_b16 v[78:79], v9 offset:18944
    s_waitcnt lgkmcnt(8)
    v_mfma_f32_32x32x16_bf16 v[48:63], v[84:87], v[148:151], v[48:63]
    ds_read_b64_tr_b16 v[80:81], v9 offset:20480
    ds_read_b64_tr_b16 v[82:83], v9 offset:20992
    s_waitcnt lgkmcnt(8)
    v_mfma_f32_32x32x16_bf16 v[48:63], v[64:67], v[152:155], v[48:63]
    ds_read_b64_tr_b16 v[84:85], v9 offset:22528
    ds_read_b64_tr_b16 v[86:87], v9 offset:23040
    s_waitcnt lgkmcnt(8)
    v_mfma_f32_32x32x16_bf16 v[48:63], v[68:71], v[156:159], v[48:63]
    ds_read_b64_tr_b16 v[64:65], v9 offset:24576
    ds_read_b64_tr_b16 v[66:67], v9 offset:25088
    s_waitcnt lgkmcnt(8)
    v_mfma_f32_32x32x16_bf16 v[48:63], v[72:75], v[160:163], v[48:63]
    ds_read_b64_tr_b16 v[68:69], v9 offset:26624
    ds_read_b64_tr_b16 v[70:71], v9 offset:27136
    s_waitcnt lgkmcnt(8)
    v_mfma_f32_32x32x16_bf16 v[48:63], v[76:79], v[164:167], v[48:63]
    ds_read_b64_tr_b16 v[72:73], v9 offset:28672
    ds_read_b64_tr_b16 v[74:75], v9 offset:29184
    s_waitcnt lgkmcnt(8)
    v_mfma_f32_32x32x16_bf16 v[48:63], v[80:83], v[168:171], v[48:63]
    ds_read_b64_tr_b16 v[76:77], v9 offset:30720
    ds_read_b64_tr_b16 v[78:79], v9 offset:31232
    s_waitcnt lgkmcnt(8)
    v_mfma_f32_32x32x16_bf16 v[48:63], v[84:87], v[172:175], v[48:63]
    s_waitcnt vmcnt(5)
    s_barrier
    ds_read_b64_tr_b16 v[80:81], v9 offset:32768
    ds_read_b64_tr_b16 v[82:83], v9 offset:33280
    s_waitcnt lgkmcnt(8)
    v_mfma_f32_32x32x16_bf16 v[48:63], v[64:67], v[176:179], v[48:63]
    ds_read_b64_tr_b16 v[84:85], v9 offset:34816
    ds_read_b64_tr_b16 v[86:87], v9 offset:35328
    s_waitcnt lgkmcnt(8)
    v_mfma_f32_32x32x16_bf16 v[48:63], v[68:71], v[180:183], v[48:63]
    ds_read_b64_tr_b16 v[64:65], v9 offset:36864
    ds_read_b64_tr_b16 v[66:67], v9 offset:37376
    s_waitcnt lgkmcnt(8)
    v_mfma_f32_32x32x16_bf16 v[48:63], v[72:75], v[184:187], v[48:63]
    ds_read_b64_tr_b16 v[68:69], v9 offset:38912
    ds_read_b64_tr_b16 v[70:71], v9 offset:39424
    s_waitcnt lgkmcnt(8)
    v_mfma_f32_32x32x16_bf16 v[48:63], v[76:79], v[188:191], v[48:63]
    ds_read_b64_tr_b16 v[72:73], v9 offset:40960
    ds_read_b64_tr_b16 v[74:75], v9 offset:41472
    s_waitcnt lgkmcnt(8)
    v_mfma_f32_32x32x16_bf16 v[48:63], v[80:83], v[192:195], v[48:63]
    ds_read_b64_tr_b16 v[76:77], v9 offset:43008
    ds_read_b64_tr_b16 v[78:79], v9 offset:43520
    s_waitcnt lgkmcnt(8)
    v_mfma_f32_32x32x16_bf16 v[48:63], v[84:87], v[196:199], v[48:63]
    ds_read_b64_tr_b16 v[80:81], v9 offset:45056
    ds_read_b64_tr_b16 v[82:83], v9 offset:45568
    s_waitcnt lgkmcnt(8)
    v_mfma_f32_32x32x16_bf16 v[48:63], v[64:67], v[200:203], v[48:63]
    ds_read_b64_tr_b16 v[84:85], v9 offset:47104
    ds_read_b64_tr_b16 v[86:87], v9 offset:47616
    s_waitcnt lgkmcnt(8)
    v_mfma_f32_32x32x16_bf16 v[48:63], v[68:71], v[204:207], v[48:63]
    ds_read_b64_tr_b16 v[64:65], v9 offset:49152
    ds_read_b64_tr_b16 v[66:67], v9 offset:49664
    s_waitcnt lgkmcnt(8)
    v_mfma_f32_32x32x16_bf16 v[48:63], v[72:75], v[208:211], v[48:63]
    ds_read_b64_tr_b16 v[68:69], v9 offset:51200
    ds_read_b64_tr_b16 v[70:71], v9 offset:51712
    s_waitcnt lgkmcnt(8)
    v_mfma_f32_32x32x16_bf16 v[48:63], v[76:79], v[212:215], v[48:63]
    ds_read_b64_tr_b16 v[72:73], v9 offset:53248
    ds_read_b64_tr_b16 v[74:75], v9 offset:53760
    s_waitcnt lgkmcnt(8)
    v_mfma_f32_32x32x16_bf16 v[48:63], v[80:83], v[216:219], v[48:63]
    ds_read_b64_tr_b16 v[76:77], v9 offset:55296
    ds_read_b64_tr_b16 v[78:79], v9 offset:55808
    s_waitcnt lgkmcnt(8)
    v_mfma_f32_32x32x16_bf16 v[48:63], v[84:87], v[220:223], v[48:63]
    ds_read_b64_tr_b16 v[80:81], v9 offset:57344
    ds_read_b64_tr_b16 v[82:83], v9 offset:57856
    s_waitcnt lgkmcnt(8)
    v_mfma_f32_32x32x16_bf16 v[48:63], v[64:67], v[224:227], v[48:63]
    ds_read_b64_tr_b16 v[84:85], v9 offset:59392
    ds_read_b64_tr_b16 v[86:87], v9 offset:59904
    s_waitcnt lgkmcnt(8)
    v_mfma_f32_32x32x16_bf16 v[48:63], v[68:71], v[228:231], v[48:63]
    ds_read_b64_tr_b16 v[64:65], v9 offset:61440
    ds_read_b64_tr_b16 v[66:67], v9 offset:61952
    s_waitcnt lgkmcnt(8)
    v_mfma_f32_32x32x16_bf16 v[48:63], v[72:75], v[232:235], v[48:63]
    ds_read_b64_tr_b16 v[68:69], v9 offset:63488
    ds_read_b64_tr_b16 v[70:71], v9 offset:64000
    s_waitcnt lgkmcnt(8)
    v_mfma_f32_32x32x16_bf16 v[48:63], v[76:79], v[236:239], v[48:63]
    s_waitcnt lgkmcnt(6)
    v_mfma_f32_32x32x16_bf16 v[48:63], v[80:83], v[240:243], v[48:63]
    s_waitcnt lgkmcnt(4)
    v_mfma_f32_32x32x16_bf16 v[48:63], v[84:87], v[244:247], v[48:63]
    s_waitcnt lgkmcnt(2)
    v_mfma_f32_32x32x16_bf16 v[48:63], v[64:67], v[248:251], v[48:63]
    s_waitcnt lgkmcnt(0)
    v_mfma_f32_32x32x16_bf16 v[48:63], v[68:71], v[252:255], v[48:63]
    s_waitcnt vmcnt(0)
    v_mov_b32 v12, s30
    v_mov_b32 v13, s31
    v_mov_b32 v11, 0
    s_mov_b64 exec, 1
    buffer_store_dwordx2 v[12:13], v11, s[20:23], s77 offen sc1
    s_mov_b64 exec, -1
    s_barrier
    s_mov_b32 s62, 0x3eb8aa3b
    v_mul_f32 v48, s62, v48
    v_mul_f32 v49, s62, v49
    v_mul_f32 v50, s62, v50
    v_mul_f32 v51, s62, v51
    v_mul_f32 v52, s62, v52
    v_mul_f32 v53, s62, v53
    v_mul_f32 v54, s62, v54
    v_mul_f32 v55, s62, v55
    v_mul_f32 v56, s62, v56
    v_mul_f32 v57, s62, v57
    v_mul_f32 v58, s62, v58
    v_mul_f32 v59, s62, v59
    v_mul_f32 v60, s62, v60
    v_mul_f32 v61, s62, v61
    v_mul_f32 v62, s62, v62
    v_mul_f32 v63, s62, v63
    v_cvt_pk_bf16_f32 v64, v48, v49
    v_cvt_pk_bf16_f32 v65, v50, v51
    v_cvt_pk_bf16_f32 v66, v52, v53
    v_cvt_pk_bf16_f32 v67, v54, v55
    v_cvt_pk_bf16_f32 v68, v56, v57
    v_cvt_pk_bf16_f32 v69, v58, v59
    v_cvt_pk_bf16_f32 v70, v60, v61
    v_cvt_pk_bf16_f32 v71, v62, v63
    v_mov_b32 v128, 0
    v_mov_b32 v129, 0
    v_mov_b32 v130, 0
    v_mov_b32 v131, 0
    v_mov_b32 v132, 0
    v_mov_b32 v133, 0
    v_mov_b32 v134, 0
    v_mov_b32 v135, 0
    v_mov_b32 v136, 0
    v_mov_b32 v137, 0
    v_mov_b32 v138, 0
    v_mov_b32 v139, 0
    v_mov_b32 v140, 0
    v_mov_b32 v141, 0
    v_mov_b32 v142, 0
    v_mov_b32 v143, 0
    v_mov_b32 v200, 0x3f803f80
    v_mov_b32 v201, 0x3f803f80
    v_mov_b32 v202, 0x3f803f80
    v_mov_b32 v203, 0x3f803f80
    v_mov_b32 v204, 0x3f803f80
    v_mov_b32 v205, 0x3f803f80
    v_mov_b32 v206, 0x3f803f80
    v_mov_b32 v207, 0x3f803f80
    v_mov_b32 v208, 0x3f803f80
    v_mov_b32 v209, 0x3f803f80
    v_mov_b32 v210, 0x3f803f80
    v_mov_b32 v211, 0x3f803f80
    v_mov_b32 v212, 0x3f803f80
    v_mov_b32 v213, 0x3f803f80
    v_mov_b32 v214, 0x3f803f80
    v_mov_b32 v215, 0x3f803f80
    s_lshl_b32 s62, s28, 13
    s_sub_u32 s62, 98304, s62
    s_lshl_b32 s63, s29, 11
    s_add_u32 s62, s62, s63
    v_add_u32 v248, s62, v10
    v_and_b32 v11, 15, v0
    v_lshlrev_b32 v11, 4, v11
    v_lshrrev_b32 v12, 5, v0
    v_lshl_add_u32 v11, v12, 8, v11
    s_sub_u32 s62, s62, 4096
    v_add_u32 v249, s62, v11
    v_add_u32 v250, 0x10000, v249
    s_lshl_b32 s62, s25, 2
    s_add_u32 s62, s62, s28
    s_min_u32 s59, s62, 8
    s_lshl_b32 s63, s24, 6
    s_add_u32 s62, s62, s63
    s_lshl_b32 s76, s62, 15
    s_lshl_b32 s63, s29, 11
    s_add_u32 s76, s76, s63
    s_add_u32 s76, s76, 16777216
    s_lshl_b32 s63, s26, 12
    s_add_u32 s75, s76, s63
    s_lshl_b32 s77, s62, 9
    s_lshl_b32 s63, s29, 8
    s_add_u32 s77, s77, s63
    s_add_u32 s77, s77, 65536
    v_and_b32 v253, 7, v0
    v_lshlrev_b32 v253, 3, v253
    s_add_u32 s62, s25, s29
    s_cmp_lt_u32 s62, 2
    s_cselect_b32 s78, 1, 0
    s_cbranch_scc1 L_nokv
    s_sub_u32 s62, s62, 2
    s_lshl_b32 s63, s24, 3
    s_add_u32 s63, s63, s26
    s_lshl_b32 s63, s63, 4
    s_add_u32 s62, s62, s63
    s_and_b32 s63, s27, 3
    s_lshl_b32 s47, s62, 10
    s_lshl_b32 s64, s63, 8
    s_add_u32 s47, s47, s64
    s_add_u32 s47, s47, 262144
    s_lshl_b32 s74, s62, 15
    s_lshl_b32 s64, s63, 13
    s_add_u32 s74, s74, s64
    s_add_u32 s74, s74, 2097152
    v_and_b32 v11, 1, v0
    v_lshlrev_b32 v11, 7, v11
    s_mov_b32 s61, 0
L_pkv:
    buffer_load_dwordx2 v[12:13], v11, s[20:23], s47 offen sc1
    s_add_u32 s61, s61, 1
    s_waitcnt vmcnt(0)
    v_xor_b32 v12, s32, v12
    v_xor_b32 v13, s33, v13
    v_or_b32 v12, v12, v13
    v_cmp_ne_u32 vcc, 0, v12
    s_cbranch_vccz L_pkv_ok
    s_cmp_lt_u32 s61, 0x400000
    s_cbranch_scc1 L_pkv
L_pkv_ok:
    s_lshl_b32 s62, s27, 13
    s_sub_u32 s62, 155648, s62
    s_add_u32 m0, s62, 0
    s_add_u32 s63, s74, 0
    buffer_load_dwordx4 v10, s[20:23], s63 offen sc1 lds
    s_add_u32 m0, s62, 1024
    s_add_u32 s63, s74, 1024
    buffer_load_dwordx4 v10, s[20:23], s63 offen sc1 lds
    s_add_u32 m0, s62, 2048
    s_add_u32 s63, s74, 2048
    buffer_load_dwordx4 v10, s[20:23], s63 offen sc1 lds
    s_add_u32 m0, s62, 3072
    s_add_u32 s63, s74, 3072
    buffer_load_dwordx4 v10, s[20:23], s63 offen sc1 lds
    s_add_u32 m0, s62, 4096
    s_add_u32 s63, s74, 4096
    buffer_load_dwordx4 v10, s[20:23], s63 offen sc1 lds
    s_add_u32 m0, s62, 5120
    s_add_u32 s63, s74, 5120
    buffer_load_dwordx4 v10, s[20:23], s63 offen sc1 lds
    s_add_u32 m0, s62, 6144
    s_add_u32 s63, s74, 6144
    buffer_load_dwordx4 v10, s[20:23], s63 offen sc1 lds
    s_add_u32 m0, s62, 7168
    s_add_u32 s63, s74, 7168
    buffer_load_dwordx4 v10, s[20:23], s63 offen sc1 lds
L_nokv:
    s_lshl_b32 s62, s3, 13
    s_lshl_b32 s63, s3, 16
    s_add_u32 s62, s62, s58
    s_add_u32 s63, s63, s56
    s_add_u32 m0, s62, 0
    s_nop 0
    buffer_load_dwordx4 v4, s[12:15], s63 offen lds
    s_add_u32 s3, s3, 1
    s_and_b32 s3, s3, 7
    s_mov_b32 s39, s28
    s_mov_b32 s98, 1
    s_setprio 3
    s_mov_b32 s78, 0
    s_lshl_b32 s79, s26, 3
    s_add_u32 s79, s79, s77
    s_mov_b32 s60, 0
L_att0:
    v_mfma_f32_32x32x16_bf16 v[144:159], v[120:123], v[64:67], v[88:103]
    s_cmp_eq_u32 s39, 0
    s_cbranch_scc0 L_sy0
    s_waitcnt vmcnt(1)
    s_barrier
    s_mov_b32 s39, -1
L_sy0:
    ds_read_b128 v[196:199], v248 offset:0
    s_mov_b64 exec, s[72:73]
    ds_read_b128 v[200:203], v249 offset:0
    ds_read_b128 v[204:207], v249 offset:512
    s_mov_b64 exec, -1
    s_waitcnt lgkmcnt(2)
    v_mfma_f32_32x32x16_bf16 v[160:175], v[196:199], v[64:67], v[128:143]
    s_nop 9
    v_exp_f32 v144, v144
    v_exp_f32 v145, v145
    v_exp_f32 v146, v146
    v_exp_f32 v147, v147
    v_exp_f32 v148, v148
    v_exp_f32 v149, v149
    v_exp_f32 v150, v150
    v_exp_f32 v151, v151
    v_exp_f32 v152, v152
    v_exp_f32 v153, v153
    v_exp_f32 v154, v154
    v_exp_f32 v155, v155
    s_cmp_eq_u32 s39, 1
    s_cbranch_scc0 L_sy1
    s_waitcnt vmcnt(1)
    s_barrier
    s_mov_b32 s39, -1
L_sy1:
    ds_read_b128 v[192:195], v248 offset:8192
    s_mov_b64 exec, s[72:73]
    ds_read_b128 v[208:211], v249 offset:8192
    ds_read_b128 v[212:215], v249 offset:8704
    s_mov_b64 exec, -1
    v_exp_f32 v156, v156
    v_exp_f32 v157, v157
    v_exp_f32 v158, v158
    v_exp_f32 v159, v159
    v_cvt_pk_bf16_f32 v176, v144, v145
    v_cvt_pk_bf16_f32 v177, v146, v147
    v_cvt_pk_bf16_f32 v178, v148, v149
    v_cvt_pk_bf16_f32 v179, v150, v151
    v_cvt_pk_bf16_f32 v180, v152, v153
    v_cvt_pk_bf16_f32 v181, v154, v155
    v_cvt_pk_bf16_f32 v182, v156, v157
    v_cvt_pk_bf16_f32 v183, v158, v159
    s_cmp_eq_u32 s59, 0
    s_cbranch_scc1 L_x0_0
    s_waitcnt lgkmcnt(2)
    v_mfma_f32_32x32x16_bf16 v[144:159], v[192:195], v[64:67], v[128:143]
    v_exp_f32 v160, v160
    v_exp_f32 v161, v161
    v_exp_f32 v162, v162
    v_exp_f32 v163, v163
    v_exp_f32 v164, v164
    v_exp_f32 v165, v165
    v_mfma_f32_32x32x16_bf16 v[216:231], v[200:203], v[176:179], 0
    v_exp_f32 v166, v166
    v_exp_f32 v167, v167
    v_exp_f32 v168, v168
    v_exp_f32 v169, v169
    v_exp_f32 v170, v170
    v_exp_f32 v171, v171
    v_mfma_f32_32x32x16_bf16 v[216:231], v[204:207], v[180:183], v[216:231]
    s_cmp_eq_u32 s39, 2
    s_cbranch_scc0 L_sy2
    s_waitcnt vmcnt(1)
    s_barrier
    s_mov_b32 s39, -1
L_sy2:
    ds_read_b128 v[196:199], v248 offset:16384
    s_mov_b64 exec, s[72:73]
    ds_read_b128 v[200:203], v249 offset:16384
    ds_read_b128 v[204:207], v249 offset:16896
    s_mov_b64 exec, -1
    v_exp_f32 v172, v172
    v_exp_f32 v173, v173
    v_exp_f32 v174, v174
    v_exp_f32 v175, v175
    v_cvt_pk_bf16_f32 v184, v160, v161
    v_cvt_pk_bf16_f32 v185, v162, v163
    v_cvt_pk_bf16_f32 v186, v164, v165
    v_cvt_pk_bf16_f32 v187, v166, v167
    v_cvt_pk_bf16_f32 v188, v168, v169
    v_cvt_pk_bf16_f32 v189, v170, v171
    v_cvt_pk_bf16_f32 v190, v172, v173
    v_cvt_pk_bf16_f32 v191, v174, v175
    s_cmp_ge_u32 s98, 8
    s_cbranch_scc1 L_wo1
    s_lshl_b32 s62, s3, 13
    s_lshl_b32 s63, s3, 16
    s_add_u32 s62, s62, s58
    s_add_u32 s63, s63, s56
    s_add_u32 m0, s62, 0
    s_nop 0
    buffer_load_dwordx4 v4, s[12:15], s63 offen lds
    s_add_u32 s3, s3, 1
    s_and_b32 s3, s3, 7
    s_add_u32 s98, s98, 1
L_wo1:
    s_cmp_eq_u32 s59, 1
    s_cbranch_scc1 L_x0_1
    s_waitcnt lgkmcnt(2)
    v_mfma_f32_32x32x16_bf16 v[160:175], v[196:199], v[64:67], v[128:143]
    v_exp_f32 v144, v144
    v_exp_f32 v145, v145
    v_exp_f32 v146, v146
    v_exp_f32 v147, v147
    v_exp_f32 v148, v148
    v_exp_f32 v149, v149
    v_mfma_f32_32x32x16_bf16 v[216:231], v[208:211], v[184:187], v[216:231]
    v_exp_f32 v150, v150
    v_exp_f32 v151, v151
    v_exp_f32 v152, v152
    v_exp_f32 v153, v153
    v_exp_f32 v154, v154
    v_exp_f32 v155, v155
    v_mfma_f32_32x32x16_bf16 v[216:231], v[212:215], v[188:191], v[216:231]
    s_cmp_eq_u32 s39, 3
    s_cbranch_scc0 L_sy3
    s_waitcnt vmcnt(2)
    s_barrier
    s_mov_b32 s39, -1
L_sy3:
    ds_read_b128 v[192:195], v248 offset:24576
    s_mov_b64 exec, s[72:73]
    ds_read_b128 v[208:211], v249 offset:24576
    ds_read_b128 v[212:215], v249 offset:25088
    s_mov_b64 exec, -1
    v_exp_f32 v156, v156
    v_exp_f32 v157, v157
    v_exp_f32 v158, v158
    v_exp_f32 v159, v159
    v_cvt_pk_bf16_f32 v176, v144, v145
    v_cvt_pk_bf16_f32 v177, v146, v147
    v_cvt_pk_bf16_f32 v178, v148, v149
    v_cvt_pk_bf16_f32 v179, v150, v151
    v_cvt_pk_bf16_f32 v180, v152, v153
    v_cvt_pk_bf16_f32 v181, v154, v155
    v_cvt_pk_bf16_f32 v182, v156, v157
    v_cvt_pk_bf16_f32 v183, v158, v159
    s_cmp_ge_u32 s98, 8
    s_cbranch_scc1 L_wo2
    s_lshl_b32 s62, s3, 13
    s_lshl_b32 s63, s3, 16
    s_add_u32 s62, s62, s58
    s_add_u32 s63, s63, s56
    s_add_u32 m0, s62, 0
    s_nop 0
    buffer_load_dwordx4 v4, s[12:15], s63 offen lds
    s_add_u32 s3, s3, 1
    s_and_b32 s3, s3, 7
    s_add_u32 s98, s98, 1
L_wo2:
    s_cmp_eq_u32 s59, 2
    s_cbranch_scc1 L_x0_2
    s_waitcnt lgkmcnt(2)
    v_mfma_f32_32x32x16_bf16 v[144:159], v[192:195], v[64:67], v[128:143]
    v_exp_f32 v160, v160
    v_exp_f32 v161, v161
    v_exp_f32 v162, v162
    v_exp_f32 v163, v163
    v_exp_f32 v164, v164
    v_exp_f32 v165, v165
    v_mfma_f32_32x32x16_bf16 v[216:231], v[200:203], v[176:179], v[216:231]
    v_exp_f32 v166, v166
    v_exp_f32 v167, v167
    v_exp_f32 v168, v168
    v_exp_f32 v169, v169
    v_exp_f32 v170, v170
    v_exp_f32 v171, v171
    v_mfma_f32_32x32x16_bf16 v[216:231], v[204:207], v[180:183], v[216:231]
    ds_read_b128 v[196:199], v248 offset:32768
    s_mov_b64 exec, s[72:73]
    ds_read_b128 v[200:203], v249 offset:32768
    ds_read_b128 v[204:207], v249 offset:33280
    s_mov_b64 exec, -1
    v_exp_f32 v172, v172
    v_exp_f32 v173, v173
    v_exp_f32 v174, v174
    v_exp_f32 v175, v175
    v_cvt_pk_bf16_f32 v184, v160, v161
    v_cvt_pk_bf16_f32 v185, v162, v163
    v_cvt_pk_bf16_f32 v186, v164, v165
    v_cvt_pk_bf16_f32 v187, v166, v167
    v_cvt_pk_bf16_f32 v188, v168, v169
    v_cvt_pk_bf16_f32 v189, v170, v171
    v_cvt_pk_bf16_f32 v190, v172, v173
    v_cvt_pk_bf16_f32 v191, v174, v175
    s_cmp_ge_u32 s98, 8
    s_cbranch_scc1 L_wo3
    s_lshl_b32 s62, s3, 13
    s_lshl_b32 s63, s3, 16
    s_add_u32 s62, s62, s58
    s_add_u32 s63, s63, s56
    s_add_u32 m0, s62, 0
    s_nop 0
    buffer_load_dwordx4 v4, s[12:15], s63 offen lds
    s_add_u32 s3, s3, 1
    s_and_b32 s3, s3, 7
    s_add_u32 s98, s98, 1
L_wo3:
    s_cmp_eq_u32 s59, 3
    s_cbranch_scc1 L_x0_3
    s_cmp_eq_u32 s29, 0
    s_cbranch_scc0 L_pr4_0
    s_setprio 2
L_pr4_0:
    s_waitcnt lgkmcnt(2)
    v_mfma_f32_32x32x16_bf16 v[160:175], v[196:199], v[64:67], v[128:143]
    v_exp_f32 v144, v144
    v_exp_f32 v145, v145
    v_exp_f32 v146, v146
    v_exp_f32 v147, v147
    v_exp_f32 v148, v148
    v_exp_f32 v149, v149
    v_mfma_f32_32x32x16_bf16 v[216:231], v[208:211], v[184:187], v[216:231]
    v_exp_f32 v150, v150
    v_exp_f32 v151, v151
    v_exp_f32 v152, v152
    v_exp_f32 v153, v153
    v_exp_f32 v154, v154
    v_exp_f32 v155, v155
    v_mfma_f32_32x32x16_bf16 v[216:231], v[212:215], v[188:191], v[216:231]
    ds_read_b128 v[192:195], v248 offset:40960
    s_mov_b64 exec, s[72:73]
    ds_read_b128 v[208:211], v249 offset:40960
    ds_read_b128 v[212:215], v249 offset:41472
    s_mov_b64 exec, -1
    v_exp_f32 v156, v156
    v_exp_f32 v157, v157
    v_exp_f32 v158, v158
    v_exp_f32 v159, v159
    v_cvt_pk_bf16_f32 v176, v144, v145
    v_cvt_pk_bf16_f32 v177, v146, v147
    v_cvt_pk_bf16_f32 v178, v148, v149
    v_cvt_pk_bf16_f32 v179, v150, v151
    v_cvt_pk_bf16_f32 v180, v152, v153
    v_cvt_pk_bf16_f32 v181, v154, v155
    v_cvt_pk_bf16_f32 v182, v156, v157
    v_cvt_pk_bf16_f32 v183, v158, v159
    s_cmp_ge_u32 s98, 8
    s_cbranch_scc1 L_wo4
    s_lshl_b32 s62, s3, 13
    s_lshl_b32 s63, s3, 16
    s_add_u32 s62, s62, s58
    s_add_u32 s63, s63, s56
    s_add_u32 m0, s62, 0
    s_nop 0
    buffer_load_dwordx4 v4, s[12:15], s63 offen lds
    s_add_u32 s3, s3, 1
    s_and_b32 s3, s3, 7
    s_add_u32 s98, s98, 1
L_wo4:
    s_cmp_eq_u32 s59, 4
    s_cbranch_scc1 L_x0_4
    s_waitcnt lgkmcnt(2)
    v_mfma_f32_32x32x16_bf16 v[144:159], v[192:195], v[64:67], v[128:143]
    v_exp_f32 v160, v160
    v_exp_f32 v161, v161
    v_exp_f32 v162, v162
    v_exp_f32 v163, v163
    v_exp_f32 v164, v164
    v_exp_f32 v165, v165
    v_mfma_f32_32x32x16_bf16 v[216:231], v[200:203], v[176:179], v[216:231]
    v_exp_f32 v166, v166
    v_exp_f32 v167, v167
    v_exp_f32 v168, v168
    v_exp_f32 v169, v169
    v_exp_f32 v170, v170
    v_exp_f32 v171, v171
    v_mfma_f32_32x32x16_bf16 v[216:231], v[204:207], v[180:183], v[216:231]
    ds_read_b128 v[196:199], v248 offset:49152
    s_mov_b64 exec, s[72:73]
    ds_read_b128 v[200:203], v249 offset:49152
    ds_read_b128 v[204:207], v249 offset:49664
    s_mov_b64 exec, -1
    v_exp_f32 v172, v172
    v_exp_f32 v173, v173
    v_exp_f32 v174, v174
    v_exp_f32 v175, v175
    v_cvt_pk_bf16_f32 v184, v160, v161
    v_cvt_pk_bf16_f32 v185, v162, v163
    v_cvt_pk_bf16_f32 v186, v164, v165
    v_cvt_pk_bf16_f32 v187, v166, v167
    v_cvt_pk_bf16_f32 v188, v168, v169
    v_cvt_pk_bf16_f32 v189, v170, v171
    v_cvt_pk_bf16_f32 v190, v172, v173
    v_cvt_pk_bf16_f32 v191, v174, v175
    s_cmp_ge_u32 s98, 8
    s_cbranch_scc1 L_wo5
    s_lshl_b32 s62, s3, 13
    s_lshl_b32 s63, s3, 16
    s_add_u32 s62, s62, s58
    s_add_u32 s63, s63, s56
    s_add_u32 m0, s62, 0
    s_nop 0
    buffer_load_dwordx4 v4, s[12:15], s63 offen lds
    s_add_u32 s3, s3, 1
    s_and_b32 s3, s3, 7
    s_add_u32 s98, s98, 1
L_wo5:
    s_cmp_eq_u32 s59, 5
    s_cbranch_scc1 L_x0_5
    s_cmp_eq_u32 s29, 1
    s_cbranch_scc0 L_pr6_1
    s_setprio 2
L_pr6_1:
    s_waitcnt lgkmcnt(2)
    v_mfma_f32_32x32x16_bf16 v[160:175], v[196:199], v[64:67], v[128:143]
    v_exp_f32 v144, v144
    v_exp_f32 v145, v145
    v_exp_f32 v146, v146
    v_exp_f32 v147, v147
    v_exp_f32 v148, v148
    v_exp_f32 v149, v149
    v_mfma_f32_32x32x16_bf16 v[216:231], v[208:211], v[184:187], v[216:231]
    v_exp_f32 v150, v150
    v_exp_f32 v151, v151
    v_exp_f32 v152, v152
    v_exp_f32 v153, v153
    v_exp_f32 v154, v154
    v_exp_f32 v155, v155
    v_mfma_f32_32x32x16_bf16 v[216:231], v[212:215], v[188:191], v[216:231]
    ds_read_b128 v[192:195], v248 offset:57344
    s_mov_b64 exec, s[72:73]
    ds_read_b128 v[208:211], v249 offset:57344
    ds_read_b128 v[212:215], v249 offset:57856
    s_mov_b64 exec, -1
    v_exp_f32 v156, v156
    v_exp_f32 v157, v157
    v_exp_f32 v158, v158
    v_exp_f32 v159, v159
    v_cvt_pk_bf16_f32 v176, v144, v145
    v_cvt_pk_bf16_f32 v177, v146, v147
    v_cvt_pk_bf16_f32 v178, v148, v149
    v_cvt_pk_bf16_f32 v179, v150, v151
    v_cvt_pk_bf16_f32 v180, v152, v153
    v_cvt_pk_bf16_f32 v181, v154, v155
    v_cvt_pk_bf16_f32 v182, v156, v157
    v_cvt_pk_bf16_f32 v183, v158, v159
    s_cmp_ge_u32 s98, 8
    s_cbranch_scc1 L_wo6
    s_lshl_b32 s62, s3, 13
    s_lshl_b32 s63, s3, 16
    s_add_u32 s62, s62, s58
    s_add_u32 s63, s63, s56
    s_add_u32 m0, s62, 0
    s_nop 0
    buffer_load_dwordx4 v4, s[12:15], s63 offen lds
    s_add_u32 s3, s3, 1
    s_and_b32 s3, s3, 7
    s_add_u32 s98, s98, 1
L_wo6:
    s_cmp_eq_u32 s59, 6
    s_cbranch_scc1 L_x0_6
    s_waitcnt lgkmcnt(2)
    v_mfma_f32_32x32x16_bf16 v[144:159], v[192:195], v[64:67], v[104:119]
    v_exp_f32 v160, v160
    v_exp_f32 v161, v161
    v_exp_f32 v162, v162
    v_exp_f32 v163, v163
    v_exp_f32 v164, v164
    v_exp_f32 v165, v165
    v_mfma_f32_32x32x16_bf16 v[216:231], v[200:203], v[176:179], v[216:231]
    v_exp_f32 v166, v166
    v_exp_f32 v167, v167
    v_exp_f32 v168, v168
    v_exp_f32 v169, v169
    v_exp_f32 v170, v170
    v_exp_f32 v171, v171
    v_mfma_f32_32x32x16_bf16 v[216:231], v[204:207], v[180:183], v[216:231]
    s_mov_b64 exec, s[72:73]
    ds_read_b128 v[200:203], v250 offset:0
    ds_read_b128 v[204:207], v250 offset:512
    s_mov_b64 exec, -1
    v_exp_f32 v172, v172
    v_exp_f32 v173, v173
    v_exp_f32 v174, v174
    v_exp_f32 v175, v175
    v_cvt_pk_bf16_f32 v184, v160, v161
    v_cvt_pk_bf16_f32 v185, v162, v163
    v_cvt_pk_bf16_f32 v186, v164, v165
    v_cvt_pk_bf16_f32 v187, v166, v167
    v_cvt_pk_bf16_f32 v188, v168, v169
    v_cvt_pk_bf16_f32 v189, v170, v171
    v_cvt_pk_bf16_f32 v190, v172, v173
    v_cvt_pk_bf16_f32 v191, v174, v175
    s_cmp_ge_u32 s98, 8
    s_cbranch_scc1 L_wo7
    s_lshl_b32 s62, s3, 13
    s_lshl_b32 s63, s3, 16
    s_add_u32 s62, s62, s58
    s_add_u32 s63, s63, s56
    s_add_u32 m0, s62, 0
    s_nop 0
    buffer_load_dwordx4 v4, s[12:15], s63 offen lds
    s_add_u32 s3, s3, 1
    s_and_b32 s3, s3, 7
    s_add_u32 s98, s98, 1
L_wo7:
    s_cmp_eq_u32 s59, 7
    s_cbranch_scc1 L_x0_7
    s_waitcnt lgkmcnt(2)
    v_exp_f32 v144, v144
    v_exp_f32 v145, v145
    v_exp_f32 v146, v146
    v_exp_f32 v147, v147
    v_exp_f32 v148, v148
    v_exp_f32 v149, v149
    v_mfma_f32_32x32x16_bf16 v[216:231], v[208:211], v[184:187], v[216:231]
    v_exp_f32 v150, v150
    v_exp_f32 v151, v151
    v_exp_f32 v152, v152
    v_exp_f32 v153, v153
    v_exp_f32 v154, v154
    v_exp_f32 v155, v155
    v_mfma_f32_32x32x16_bf16 v[216:231], v[212:215], v[188:191], v[216:231]
    v_exp_f32 v156, v156
    v_exp_f32 v157, v157
    v_exp_f32 v158, v158
    v_exp_f32 v159, v159
    v_cvt_pk_bf16_f32 v176, v144, v145
    v_cvt_pk_bf16_f32 v177, v146, v147
    v_cvt_pk_bf16_f32 v178, v148, v149
    v_cvt_pk_bf16_f32 v179, v150, v151
    v_cvt_pk_bf16_f32 v180, v152, v153
    v_cvt_pk_bf16_f32 v181, v154, v155
    v_cvt_pk_bf16_f32 v182, v156, v157
    v_cvt_pk_bf16_f32 v183, v158, v159
    s_waitcnt lgkmcnt(0)
    s_nop 0
    v_mfma_f32_32x32x16_bf16 v[216:231], v[200:203], v[176:179], v[216:231]
    v_mfma_f32_32x32x16_bf16 v[216:231], v[204:207], v[180:183], v[216:231]
L_fin0:
    s_nop 11
    v_mov_b32 v11, v224
    v_rcp_f32 v12, v224
    v_fma_f32 v11, v216, 0, v11
    v_fma_f32 v11, v217, 0, v11
    v_fma_f32 v11, v218, 0, v11
    v_fma_f32 v11, v219, 0, v11
    v_fma_f32 v11, v220, 0, v11
    v_fma_f32 v11, v221, 0, v11
    v_fma_f32 v11, v222, 0, v11
    v_fma_f32 v11, v223, 0, v11
    s_mov_b32 s62, 0x71800000
    s_mov_b32 s63, 0x0d800000
    v_cmp_ngt_f32 vcc, s62, v11
    v_cmp_nlt_f32 s[64:65], s63, v11
    v_mul_f32 v216, v216, v12
    v_mul_f32 v217, v217, v12
    v_mul_f32 v218, v218, v12
    v_mul_f32 v219, v219, v12
    v_mul_f32 v220, v220, v12
    v_mul_f32 v221, v221, v12
    v_mul_f32 v222, v222, v12
    v_mul_f32 v223, v223, v12
    s_or_b64 vcc, vcc, s[64:65]
    s_cbranch_scc1 L_fb0
L_ok0:
    v_cvt_pk_bf16_f32 v216, v216, v217
    v_cvt_pk_bf16_f32 v217, v218, v219
    v_cvt_pk_bf16_f32 v218, v220, v221
    v_cvt_pk_bf16_f32 v219, v222, v223
    buffer_store_dwordx4 v[216:219], v10, s[20:23], s75 offen offset:0 sc1
L_wor:
    s_cmp_ge_u32 s98, 8
    s_cbranch_scc1 L_wod
    s_lshl_b32 s62, s3, 13
    s_lshl_b32 s63, s3, 16
    s_add_u32 s62, s62, s58
    s_add_u32 s63, s63, s56
    s_add_u32 m0, s62, 0
    s_nop 0
    buffer_load_dwordx4 v4, s[12:15], s63 offen lds
    s_add_u32 s3, s3, 1
    s_and_b32 s3, s3, 7
    s_add_u32 s98, s98, 1
    s_branch L_wor
L_wod:
    s_mov_b32 s99, 0
    s_cmp_eq_u32 s60, 0
    s_cbranch_scc1 L_rc0
    v_and_b32 v11, 31, v0
    v_bfe_u32 v12, v0, 5, 1
    v_lshlrev_b32 v12, 2, v12
    v_sub_u32 v11, v11, v12
    v_mov_b32 v12, 0xf149f2ca
    v_mov_b32 v13, 0
    v_cmp_le_i32 vcc, 0, v11
    s_nop 1
    v_cndmask_b32 v88, v12, v13, vcc
    v_cndmask_b32 v104, v13, v12, vcc
    v_cmp_le_i32 vcc, 1, v11
    s_nop 1
    v_cndmask_b32 v89, v12, v13, vcc
    v_cndmask_b32 v105, v13, v12, vcc
    v_cmp_le_i32 vcc, 2, v11
    s_nop 1
    v_cndmask_b32 v90, v12, v13, vcc
    v_cndmask_b32 v106, v13, v12, vcc
    v_cmp_le_i32 vcc, 3, v11
    s_nop 1
    v_cndmask_b32 v91, v12, v13, vcc
    v_cndmask_b32 v107, v13, v12, vcc
    v_cmp_le_i32 vcc, 8, v11
    s_nop 1
    v_cndmask_b32 v92, v12, v13, vcc
    v_cndmask_b32 v108, v13, v12, vcc
    v_cmp_le_i32 vcc, 9, v11
    s_nop 1
    v_cndmask_b32 v93, v12, v13, vcc
    v_cndmask_b32 v109, v13, v12, vcc
    v_cmp_le_i32 vcc, 10, v11
    s_nop 1
    v_cndmask_b32 v94, v12, v13, vcc
    v_cndmask_b32 v110, v13, v12, vcc
    v_cmp_le_i32 vcc, 11, v11
    s_nop 1
    v_cndmask_b32 v95, v12, v13, vcc
    v_cndmask_b32 v111, v13, v12, vcc
    v_cmp_le_i32 vcc, 16, v11
    s_nop 1
    v_cndmask_b32 v96, v12, v13, vcc
    v_cndmask_b32 v112, v13, v12, vcc
    v_cmp_le_i32 vcc, 17, v11
    s_nop 1
    v_cndmask_b32 v97, v12, v13, vcc
    v_cndmask_b32 v113, v13, v12, vcc
    v_cmp_le_i32 vcc, 18, v11
    s_nop 1
    v_cndmask_b32 v98, v12, v13, vcc
    v_cndmask_b32 v114, v13, v12, vcc
    v_cmp_le_i32 vcc, 19, v11
    s_nop 1
    v_cndmask_b32 v99, v12, v13, vcc
    v_cndmask_b32 v115, v13, v12, vcc
    v_cmp_le_i32 vcc, 24, v11
    s_nop 1
    v_cndmask_b32 v100, v12, v13, vcc
    v_cndmask_b32 v116, v13, v12, vcc
    v_cmp_le_i32 vcc, 25, v11
    s_nop 1
    v_cndmask_b32 v101, v12, v13, vcc
    v_cndmask_b32 v117, v13, v12, vcc
    v_cmp_le_i32 vcc, 26, v11
    s_nop 1
    v_cndmask_b32 v102, v12, v13, vcc
    v_cndmask_b32 v118, v13, v12, vcc
    v_cmp_le_i32 vcc, 27, v11
    s_nop 1
    v_cndmask_b32 v103, v12, v13, vcc
    v_cndmask_b32 v119, v13, v12, vcc
    v_mov_b32 v128, 0
    v_mov_b32 v129, 0
    v_mov_b32 v130, 0
    v_mov_b32 v131, 0
    v_mov_b32 v132, 0
    v_mov_b32 v133, 0
    v_mov_b32 v134, 0
    v_mov_b32 v135, 0
    v_mov_b32 v136, 0
    v_mov_b32 v137, 0
    v_mov_b32 v138, 0
    v_mov_b32 v139, 0
    v_mov_b32 v140, 0
    v_mov_b32 v141, 0
    v_mov_b32 v142, 0
    v_mov_b32 v143, 0
L_rc0:
    v_add_u32 v248, 1024, v248
    v_add_u32 v249, 1024, v249
    v_add_u32 v250, 1024, v250
    s_mov_b32 s60, 0
L_att1:
    ds_read_b128 v[196:199], v248 offset:0
    s_mov_b64 exec, s[72:73]
    ds_read_b128 v[200:203], v249 offset:0
    ds_read_b128 v[204:207], v249 offset:512
    s_mov_b64 exec, -1
    v_mfma_f32_32x32x16_bf16 v[144:159], v[124:127], v[68:71], v[88:103]
    s_cmp_eq_u32 s29, 0
    s_cbranch_scc0 L_pr9_0
    s_setprio 1
L_pr9_0:
    s_waitcnt lgkmcnt(2)
    v_mfma_f32_32x32x16_bf16 v[160:175], v[196:199], v[68:71], v[128:143]
    s_nop 9
    v_exp_f32 v144, v144
    v_exp_f32 v145, v145
    v_exp_f32 v146, v146
    v_exp_f32 v147, v147
    v_exp_f32 v148, v148
    v_exp_f32 v149, v149
    v_exp_f32 v150, v150
    v_exp_f32 v151, v151
    v_exp_f32 v152, v152
    v_exp_f32 v153, v153
    v_exp_f32 v154, v154
    v_exp_f32 v155, v155
    ds_read_b128 v[192:195], v248 offset:8192
    s_mov_b64 exec, s[72:73]
    ds_read_b128 v[208:211], v249 offset:8192
    ds_read_b128 v[212:215], v249 offset:8704
    s_mov_b64 exec, -1
    v_exp_f32 v156, v156
    v_exp_f32 v157, v157
    v_exp_f32 v158, v158
    v_exp_f32 v159, v159
    v_cvt_pk_bf16_f32 v176, v144, v145
    v_cvt_pk_bf16_f32 v177, v146, v147
    v_cvt_pk_bf16_f32 v178, v148, v149
    v_cvt_pk_bf16_f32 v179, v150, v151
    v_cvt_pk_bf16_f32 v180, v152, v153
    v_cvt_pk_bf16_f32 v181, v154, v155
    v_cvt_pk_bf16_f32 v182, v156, v157
    v_cvt_pk_bf16_f32 v183, v158, v159
    s_cmp_eq_u32 s59, 0
    s_cbranch_scc1 L_x1_0
    s_waitcnt lgkmcnt(2)
    v_mfma_f32_32x32x16_bf16 v[144:159], v[192:195], v[68:71], v[128:143]
    v_exp_f32 v160, v160
    v_exp_f32 v161, v161
    v_exp_f32 v162, v162
    v_exp_f32 v163, v163
    v_exp_f32 v164, v164
    v_exp_f32 v165, v165
    v_mfma_f32_32x32x16_bf16 v[216:231], v[200:203], v[176:179], 0
    v_exp_f32 v166, v166
    v_exp_f32 v167, v167
    v_exp_f32 v168, v168
    v_exp_f32 v169, v169
    v_exp_f32 v170, v170
    v_exp_f32 v171, v171
    v_mfma_f32_32x32x16_bf16 v[216:231], v[204:207], v[180:183], v[216:231]
    ds_read_b128 v[196:199], v248 offset:16384
    s_mov_b64 exec, s[72:73]
    ds_read_b128 v[200:203], v249 offset:16384
    ds_read_b128 v[204:207], v249 offset:16896
    s_mov_b64 exec, -1
    v_exp_f32 v172, v172
    v_exp_f32 v173, v173
    v_exp_f32 v174, v174
    v_exp_f32 v175, v175
    v_cvt_pk_bf16_f32 v184, v160, v161
    v_cvt_pk_bf16_f32 v185, v162, v163
    v_cvt_pk_bf16_f32 v186, v164, v165
    v_cvt_pk_bf16_f32 v187, v166, v167
    v_cvt_pk_bf16_f32 v188, v168, v169
    v_cvt_pk_bf16_f32 v189, v170, v171
    v_cvt_pk_bf16_f32 v190, v172, v173
    v_cvt_pk_bf16_f32 v191, v174, v175
    s_cmp_eq_u32 s59, 1
    s_cbranch_scc1 L_x1_1
    s_cmp_eq_u32 s29, 1
    s_cbranch_scc0 L_pr11_1
    s_setprio 1
L_pr11_1:
    s_waitcnt lgkmcnt(2)
    v_mfma_f32_32x32x16_bf16 v[160:175], v[196:199], v[68:71], v[128:143]
    v_exp_f32 v144, v144
    v_exp_f32 v145, v145
    v_exp_f32 v146, v146
    v_exp_f32 v147, v147
    v_exp_f32 v148, v148
    v_exp_f32 v149, v149
    v_mfma_f32_32x32x16_bf16 v[216:231], v[208:211], v[184:187], v[216:231]
    v_exp_f32 v150, v150
    v_exp_f32 v151, v151
    v_exp_f32 v152, v152
    v_exp_f32 v153, v153
    v_exp_f32 v154, v154
    v_exp_f32 v155, v155
    v_mfma_f32_32x32x16_bf16 v[216:231], v[212:215], v[188:191], v[216:231]
    ds_read_b128 v[192:195], v248 offset:24576
    s_mov_b64 exec, s[72:73]
    ds_read_b128 v[208:211], v249 offset:24576
    ds_read_b128 v[212:215], v249 offset:25088
    s_mov_b64 exec, -1
    v_exp_f32 v156, v156
    v_exp_f32 v157, v157
    v_exp_f32 v158, v158
    v_exp_f32 v159, v159
    v_cvt_pk_bf16_f32 v176, v144, v145
    v_cvt_pk_bf16_f32 v177, v146, v147
    v_cvt_pk_bf16_f32 v178, v148, v149
    v_cvt_pk_bf16_f32 v179, v150, v151
    v_cvt_pk_bf16_f32 v180, v152, v153
    v_cvt_pk_bf16_f32 v181, v154, v155
    v_cvt_pk_bf16_f32 v182, v156, v157
    v_cvt_pk_bf16_f32 v183, v158, v159
    s_waitcnt vmcnt(0)
    v_mov_b32 v12, s30
    v_mov_b32 v13, s31
    v_mov_b32 v11, 0
    s_mov_b64 exec, 1
    buffer_store_dwordx2 v[12:13], v11, s[20:23], s79 offen sc1
    s_mov_b64 exec, -1
    s_mov_b32 s78, 1
    s_cmp_eq_u32 s59, 2
    s_cbranch_scc1 L_x1_2
    s_waitcnt lgkmcnt(2)
    v_mfma_f32_32x32x16_bf16 v[144:159], v[192:195], v[68:71], v[128:143]
    v_exp_f32 v160, v160
    v_exp_f32 v161, v161
    v_exp_f32 v162, v162
    v_exp_f32 v163, v163
    v_exp_f32 v164, v164
    v_exp_f32 v165, v165
    v_mfma_f32_32x32x16_bf16 v[216:231], v[200:203], v[176:179], v[216:231]
    v_exp_f32 v166, v166
    v_exp_f32 v167, v167
    v_exp_f32 v168, v168
    v_exp_f32 v169, v169
    v_exp_f32 v170, v170
    v_exp_f32 v171, v171
    v_mfma_f32_32x32x16_bf16 v[216:231], v[204:207], v[180:183], v[216:231]
    ds_read_b128 v[196:199], v248 offset:32768
    s_mov_b64 exec, s[72:73]
    ds_read_b128 v[200:203], v249 offset:32768
    ds_read_b128 v[204:207], v249 offset:33280
    s_mov_b64 exec, -1
    v_exp_f32 v172, v172
    v_exp_f32 v173, v173
    v_exp_f32 v174, v174
    v_exp_f32 v175, v175
    v_cvt_pk_bf16_f32 v184, v160, v161
    v_cvt_pk_bf16_f32 v185, v162, v163
    v_cvt_pk_bf16_f32 v186, v164, v165
    v_cvt_pk_bf16_f32 v187, v166, v167
    v_cvt_pk_bf16_f32 v188, v168, v169
    v_cvt_pk_bf16_f32 v189, v170, v171
    v_cvt_pk_bf16_f32 v190, v172, v173
    v_cvt_pk_bf16_f32 v191, v174, v175
    s_cmp_eq_u32 s59, 3
    s_cbranch_scc1 L_x1_3
    s_waitcnt lgkmcnt(2)
    v_mfma_f32_32x32x16_bf16 v[160:175], v[196:199], v[68:71], v[128:143]
    v_exp_f32 v144, v144
    v_exp_f32 v145, v145
    v_exp_f32 v146, v146
    v_exp_f32 v147, v147
    v_exp_f32 v148, v148
    v_exp_f32 v149, v149
    v_mfma_f32_32x32x16_bf16 v[216:231], v[208:211], v[184:187], v[216:231]
    v_exp_f32 v150, v150
    v_exp_f32 v151, v151
    v_exp_f32 v152, v152
    v_exp_f32 v153, v153
    v_exp_f32 v154, v154
    v_exp_f32 v155, v155
    v_mfma_f32_32x32x16_bf16 v[216:231], v[212:215], v[188:191], v[216:231]
    ds_read_b128 v[192:195], v248 offset:40960
    s_mov_b64 exec, s[72:73]
    ds_read_b128 v[208:211], v249 offset:40960
    ds_read_b128 v[212:215], v249 offset:41472
    s_mov_b64 exec, -1
    v_exp_f32 v156, v156
    v_exp_f32 v157, v157
    v_exp_f32 v158, v158
    v_exp_f32 v159, v159
    v_cvt_pk_bf16_f32 v176, v144, v145
    v_cvt_pk_bf16_f32 v177, v146, v147
    v_cvt_pk_bf16_f32 v178, v148, v149
    v_cvt_pk_bf16_f32 v179, v150, v151
    v_cvt_pk_bf16_f32 v180, v152, v153
    v_cvt_pk_bf16_f32 v181, v154, v155
    v_cvt_pk_bf16_f32 v182, v156, v157
    v_cvt_pk_bf16_f32 v183, v158, v159
    s_cmp_eq_u32 s99, 2
    s_cbranch_scc1 L_tl4
    buffer_load_dwordx2 v[14:15], v253, s[20:23], s77 offen sc1
    s_mov_b32 s99, 1
L_tl4:
    s_cmp_eq_u32 s59, 4
    s_cbranch_scc1 L_x1_4
    s_cmp_eq_u32 s29, 0
    s_cbranch_scc0 L_pr14_0
    s_setprio 0
L_pr14_0:
    s_waitcnt lgkmcnt(2)
    v_mfma_f32_32x32x16_bf16 v[144:159], v[192:195], v[68:71], v[128:143]
    v_exp_f32 v160, v160
    v_exp_f32 v161, v161
    v_exp_f32 v162, v162
    v_exp_f32 v163, v163
    v_exp_f32 v164, v164
    v_exp_f32 v165, v165
    v_mfma_f32_32x32x16_bf16 v[216:231], v[200:203], v[176:179], v[216:231]
    v_exp_f32 v166, v166
    v_exp_f32 v167, v167
    v_exp_f32 v168, v168
    v_exp_f32 v169, v169
    v_exp_f32 v170, v170
    v_exp_f32 v171, v171
    v_mfma_f32_32x32x16_bf16 v[216:231], v[204:207], v[180:183], v[216:231]
    ds_read_b128 v[196:199], v248 offset:49152
    s_mov_b64 exec, s[72:73]
    ds_read_b128 v[200:203], v249 offset:49152
    ds_read_b128 v[204:207], v249 offset:49664
    s_mov_b64 exec, -1
    v_exp_f32 v172, v172
    v_exp_f32 v173, v173
    v_exp_f32 v174, v174
    v_exp_f32 v175, v175
    v_cvt_pk_bf16_f32 v184, v160, v161
    v_cvt_pk_bf16_f32 v185, v162, v163
    v_cvt_pk_bf16_f32 v186, v164, v165
    v_cvt_pk_bf16_f32 v187, v166, v167
    v_cvt_pk_bf16_f32 v188, v168, v169
    v_cvt_pk_bf16_f32 v189, v170, v171
    v_cvt_pk_bf16_f32 v190, v172, v173
    v_cvt_pk_bf16_f32 v191, v174, v175
    s_cmp_eq_u32 s59, 5
    s_cbranch_scc1 L_x1_5
    s_waitcnt lgkmcnt(2)
    v_mfma_f32_32x32x16_bf16 v[160:175], v[196:199], v[68:71], v[128:143]
    v_exp_f32 v144, v144
    v_exp_f32 v145, v145
    v_exp_f32 v146, v146
    v_exp_f32 v147, v147
    v_exp_f32 v148, v148
    v_exp_f32 v149, v149
    v_mfma_f32_32x32x16_bf16 v[216:231], v[208:211], v[184:187], v[216:231]
    v_exp_f32 v150, v150
    v_exp_f32 v151, v151
    v_exp_f32 v152, v152
    v_exp_f32 v153, v153
    v_exp_f32 v154, v154
    v_exp_f32 v155, v155
    v_mfma_f32_32x32x16_bf16 v[216:231], v[212:215], v[188:191], v[216:231]
    ds_read_b128 v[192:195], v248 offset:57344
    s_mov_b64 exec, s[72:73]
    ds_read_b128 v[208:211], v249 offset:57344
    ds_read_b128 v[212:215], v249 offset:57856
    s_mov_b64 exec, -1
    v_exp_f32 v156, v156
    v_exp_f32 v157, v157
    v_exp_f32 v158, v158
    v_exp_f32 v159, v159
    v_cvt_pk_bf16_f32 v176, v144, v145
    v_cvt_pk_bf16_f32 v177, v146, v147
    v_cvt_pk_bf16_f32 v178, v148, v149
    v_cvt_pk_bf16_f32 v179, v150, v151
    v_cvt_pk_bf16_f32 v180, v152, v153
    v_cvt_pk_bf16_f32 v181, v154, v155
    v_cvt_pk_bf16_f32 v182, v156, v157
    v_cvt_pk_bf16_f32 v183, v158, v159
    s_cmp_lg_u32 s99, 1
    s_cbranch_scc1 L_tc6
    s_waitcnt vmcnt(0)
    v_xor_b32 v14, s30, v14
    v_xor_b32 v15, s31, v15
    v_or_b32 v14, v14, v15
    v_cmp_ne_u32 vcc, 0, v14
    s_cbranch_vccnz L_tc6
    s_add_u32 s62, s76, 0
    buffer_load_dwordx4 v[48:51], v10, s[20:23], s62 offen sc1
    s_add_u32 s62, s62, 4096
    buffer_load_dwordx4 v[52:55], v10, s[20:23], s62 offen sc1
    s_add_u32 s62, s62, 4096
    buffer_load_dwordx4 v[56:59], v10, s[20:23], s62 offen sc1
    s_add_u32 s62, s62, 4096
    buffer_load_dwordx4 v[60:63], v10, s[20:23], s62 offen sc1
    s_add_u32 s62, s62, 4096
    buffer_load_dwordx4 v[72:75], v10, s[20:23], s62 offen sc1
    s_add_u32 s62, s62, 4096
    buffer_load_dwordx4 v[76:79], v10, s[20:23], s62 offen sc1
    s_add_u32 s62, s62, 4096
    buffer_load_dwordx4 v[80:83], v10, s[20:23], s62 offen sc1
    s_add_u32 s62, s62, 4096
    buffer_load_dwordx4 v[84:87], v10, s[20:23], s62 offen sc1
    s_mov_b32 s99, 2
L_tc6:
    s_cmp_eq_u32 s99, 2
    s_cbranch_scc1 L_tl6
    buffer_load_dwordx2 v[14:15], v253, s[20:23], s77 offen sc1
    s_mov_b32 s99, 1
L_tl6:
    s_cmp_eq_u32 s59, 6
    s_cbranch_scc1 L_x1_6
    s_cmp_eq_u32 s29, 1
    s_cbranch_scc0 L_pr16_1
    s_setprio 0
L_pr16_1:
    s_waitcnt lgkmcnt(2)
    v_mfma_f32_32x32x16_bf16 v[144:159], v[192:195], v[68:71], v[104:119]
    v_exp_f32 v160, v160
    v_exp_f32 v161, v161
    v_exp_f32 v162, v162
    v_exp_f32 v163, v163
    v_exp_f32 v164, v164
    v_exp_f32 v165, v165
    v_mfma_f32_32x32x16_bf16 v[216:231], v[200:203], v[176:179], v[216:231]
    v_exp_f32 v166, v166
    v_exp_f32 v167, v167
    v_exp_f32 v168, v168
    v_exp_f32 v169, v169
    v_exp_f32 v170, v170
    v_exp_f32 v171, v171
    v_mfma_f32_32x32x16_bf16 v[216:231], v[204:207], v[180:183], v[216:231]
    s_mov_b64 exec, s[72:73]
    ds_read_b128 v[200:203], v250 offset:0
    ds_read_b128 v[204:207], v250 offset:512
    s_mov_b64 exec, -1
    v_exp_f32 v172, v172
    v_exp_f32 v173, v173
    v_exp_f32 v174, v174
    v_exp_f32 v175, v175
    v_cvt_pk_bf16_f32 v184, v160, v161
    v_cvt_pk_bf16_f32 v185, v162, v163
    v_cvt_pk_bf16_f32 v186, v164, v165
    v_cvt_pk_bf16_f32 v187, v166, v167
    v_cvt_pk_bf16_f32 v188, v168, v169
    v_cvt_pk_bf16_f32 v189, v170, v171
    v_cvt_pk_bf16_f32 v190, v172, v173
    v_cvt_pk_bf16_f32 v191, v174, v175
    s_cmp_eq_u32 s59, 7
    s_cbranch_scc1 L_x1_7
    s_waitcnt lgkmcnt(2)
    v_exp_f32 v144, v144
    v_exp_f32 v145, v145
    v_exp_f32 v146, v146
    v_exp_f32 v147, v147
    v_exp_f32 v148, v148
    v_exp_f32 v149, v149
    v_mfma_f32_32x32x16_bf16 v[216:231], v[208:211], v[184:187], v[216:231]
    v_exp_f32 v150, v150
    v_exp_f32 v151, v151
    v_exp_f32 v152, v152
    v_exp_f32 v153, v153
    v_exp_f32 v154, v154
    v_exp_f32 v155, v155
    v_mfma_f32_32x32x16_bf16 v[216:231], v[212:215], v[188:191], v[216:231]
    v_exp_f32 v156, v156
    v_exp_f32 v157, v157
    v_exp_f32 v158, v158
    v_exp_f32 v159, v159
    v_cvt_pk_bf16_f32 v176, v144, v145
    v_cvt_pk_bf16_f32 v177, v146, v147
    v_cvt_pk_bf16_f32 v178, v148, v149
    v_cvt_pk_bf16_f32 v179, v150, v151
    v_cvt_pk_bf16_f32 v180, v152, v153
    v_cvt_pk_bf16_f32 v181, v154, v155
    v_cvt_pk_bf16_f32 v182, v156, v157
    v_cvt_pk_bf16_f32 v183, v158, v159
    s_cmp_lg_u32 s99, 1
    s_cbranch_scc1 L_tc8
    s_waitcnt vmcnt(0)
    v_xor_b32 v14, s30, v14
    v_xor_b32 v15, s31, v15
    v_or_b32 v14, v14, v15
    v_cmp_ne_u32 vcc, 0, v14
    s_cbranch_vccnz L_tc8
    s_add_u32 s62, s76, 0
    buffer_load_dwordx4 v[48:51], v10, s[20:23], s62 offen sc1
    s_add_u32 s62, s62, 4096
    buffer_load_dwordx4 v[52:55], v10, s[20:23], s62 offen sc1
    s_add_u32 s62, s62, 4096
    buffer_load_dwordx4 v[56:59], v10, s[20:23], s62 offen sc1
    s_add_u32 s62, s62, 4096
    buffer_load_dwordx4 v[60:63], v10, s[20:23], s62 offen sc1
    s_add_u32 s62, s62, 4096
    buffer_load_dwordx4 v[72:75], v10, s[20:23], s62 offen sc1
    s_add_u32 s62, s62, 4096
    buffer_load_dwordx4 v[76:79], v10, s[20:23], s62 offen sc1
    s_add_u32 s62, s62, 4096
    buffer_load_dwordx4 v[80:83], v10, s[20:23], s62 offen sc1
    s_add_u32 s62, s62, 4096
    buffer_load_dwordx4 v[84:87], v10, s[20:23], s62 offen sc1
    s_mov_b32 s99, 2
L_tc8:
    s_waitcnt lgkmcnt(0)
    s_nop 0
    v_mfma_f32_32x32x16_bf16 v[216:231], v[200:203], v[176:179], v[216:231]
    v_mfma_f32_32x32x16_bf16 v[216:231], v[204:207], v[180:183], v[216:231]
L_fin1:
    s_nop 11
    v_mov_b32 v11, v224
    v_rcp_f32 v12, v224
    v_fma_f32 v11, v216, 0, v11
    v_fma_f32 v11, v217, 0, v11
    v_fma_f32 v11, v218, 0, v11
    v_fma_f32 v11, v219, 0, v11
    v_fma_f32 v11, v220, 0, v11
    v_fma_f32 v11, v221, 0, v11
    v_fma_f32 v11, v222, 0, v11
    v_fma_f32 v11, v223, 0, v11
    s_mov_b32 s62, 0x71800000
    s_mov_b32 s63, 0x0d800000
    v_cmp_ngt_f32 vcc, s62, v11
    v_cmp_nlt_f32 s[64:65], s63, v11
    v_mul_f32 v216, v216, v12
    v_mul_f32 v217, v217, v12
    v_mul_f32 v218, v218, v12
    v_mul_f32 v219, v219, v12
    v_mul_f32 v220, v220, v12
    v_mul_f32 v221, v221, v12
    v_mul_f32 v222, v222, v12
    v_mul_f32 v223, v223, v12
    s_or_b64 vcc, vcc, s[64:65]
    s_cbranch_scc1 L_fb1
L_ok1:
    v_cvt_pk_bf16_f32 v216, v216, v217
    v_cvt_pk_bf16_f32 v217, v218, v219
    v_cvt_pk_bf16_f32 v218, v220, v221
    v_cvt_pk_bf16_f32 v219, v222, v223
    v_min_u32 v216, -2, v216
    v_min_u32 v217, -2, v217
    v_min_u32 v218, -2, v218
    v_min_u32 v219, -2, v219
    buffer_store_dwordx4 v[216:219], v10, s[20:23], s75 offen offset:1024 sc1
    v_bfe_u32 v11, v0, 2, 2
    v_lshrrev_b32 v12, 5, v0
    v_lshl_add_u32 v11, v12, 2, v11
    v_lshlrev_b32 v11, 7, v11
    s_lshl_b32 s62, s29, 12
    v_add_u32 v11, s62, v11
    v_bfe_u32 v12, v0, 1, 1
    v_lshl_add_u32 v11, v12, 3, v11
    v_and_b32 v12, 1, v0
    v_lshlrev_b32 v12, 1, v12
    v_bfe_u32 v13, v0, 4, 1
    v_add_u32 v12, v12, v13
    v_bfe_u32 v13, v0, 3, 1
    v_lshlrev_b32 v13, 2, v13
    v_xor_b32 v12, v12, v13
    v_lshl_add_u32 v251, v12, 4, v11
    v_xor_b32 v252, 64, v251
    s_cmp_eq_u32 s78, 1
    s_cbranch_scc1 L_f0done
    s_waitcnt vmcnt(1)
    v_mov_b32 v12, s30
    v_mov_b32 v13, s31
    v_mov_b32 v11, 0
    s_mov_b64 exec, 1
    buffer_store_dwordx2 v[12:13], v11, s[20:23], s79 offen sc1
    s_mov_b64 exec, -1
L_f0done:
    s_add_u32 s79, s79, 128
    s_cmp_eq_u32 s99, 2
    s_cbranch_scc1 L_e0
    s_mov_b32 s61, 0
L_po0:
    buffer_load_dwordx2 v[12:13], v253, s[20:23], s77 offen sc1
    s_add_u32 s61, s61, 1
    s_waitcnt vmcnt(0)
    v_xor_b32 v12, s30, v12
    v_xor_b32 v13, s31, v13
    v_or_b32 v12, v12, v13
    v_cmp_ne_u32 vcc, 0, v12
    s_cbranch_vccz L_po0_ok
    s_cmp_lt_u32 s61, 0x400000
    s_cbranch_scc1 L_po0
L_po0_ok:
    s_add_u32 s62, s76, 0
    buffer_load_dwordx4 v[48:51], v10, s[20:23], s62 offen sc1
    s_add_u32 s62, s62, 4096
    buffer_load_dwordx4 v[52:55], v10, s[20:23], s62 offen sc1
    s_add_u32 s62, s62, 4096
    buffer_load_dwordx4 v[56:59], v10, s[20:23], s62 offen sc1
    s_add_u32 s62, s62, 4096
    buffer_load_dwordx4 v[60:63], v10, s[20:23], s62 offen sc1
    s_add_u32 s62, s62, 4096
    buffer_load_dwordx4 v[72:75], v10, s[20:23], s62 offen sc1
    s_add_u32 s62, s62, 4096
    buffer_load_dwordx4 v[76:79], v10, s[20:23], s62 offen sc1
    s_add_u32 s62, s62, 4096
    buffer_load_dwordx4 v[80:83], v10, s[20:23], s62 offen sc1
    s_add_u32 s62, s62, 4096
    buffer_load_dwordx4 v[84:87], v10, s[20:23], s62 offen sc1
    s_waitcnt vmcnt(0)
L_e0:
    s_waitcnt vmcnt(1)
    s_barrier
    ds_read_b64_tr_b16 v[232:233], v251 offset:0
    ds_read_b64_tr_b16 v[234:235], v251 offset:1024
    ds_read_b64_tr_b16 v[236:237], v252 offset:0
    ds_read_b64_tr_b16 v[238:239], v252 offset:1024
    ds_read_b64_tr_b16 v[240:241], v251 offset:8192
    ds_read_b64_tr_b16 v[242:243], v251 offset:9216
    ds_read_b64_tr_b16 v[244:245], v252 offset:8192
    ds_read_b64_tr_b16 v[246:247], v252 offset:9216
    s_waitcnt lgkmcnt(4)
    v_mfma_f32_32x32x16_bf16 v[16:31], v[232:235], v[48:51], 0
    v_mfma_f32_32x32x16_bf16 v[32:47], v[236:239], v[48:51], 0
    ds_read_b64_tr_b16 v[232:233], v251 offset:16384
    ds_read_b64_tr_b16 v[234:235], v251 offset:17408
    ds_read_b64_tr_b16 v[236:237], v252 offset:16384
    ds_read_b64_tr_b16 v[238:239], v252 offset:17408
    s_waitcnt lgkmcnt(4)
    v_mfma_f32_32x32x16_bf16 v[16:31], v[240:243], v[52:55], v[16:31]
    v_mfma_f32_32x32x16_bf16 v[32:47], v[244:247], v[52:55], v[32:47]
    ds_read_b64_tr_b16 v[240:241], v251 offset:24576
    ds_read_b64_tr_b16 v[242:243], v251 offset:25600
    ds_read_b64_tr_b16 v[244:245], v252 offset:24576
    ds_read_b64_tr_b16 v[246:247], v252 offset:25600
    s_waitcnt lgkmcnt(4)
    v_mfma_f32_32x32x16_bf16 v[16:31], v[232:235], v[56:59], v[16:31]
    v_mfma_f32_32x32x16_bf16 v[32:47], v[236:239], v[56:59], v[32:47]
    ds_read_b64_tr_b16 v[232:233], v251 offset:32768
    ds_read_b64_tr_b16 v[234:235], v251 offset:33792
    ds_read_b64_tr_b16 v[236:237], v252 offset:32768
    ds_read_b64_tr_b16 v[238:239], v252 offset:33792
    s_waitcnt lgkmcnt(4)
    v_mfma_f32_32x32x16_bf16 v[16:31], v[240:243], v[60:63], v[16:31]
    v_mfma_f32_32x32x16_bf16 v[32:47], v[244:247], v[60:63], v[32:47]
    ds_read_b64_tr_b16 v[240:241], v251 offset:40960
    ds_read_b64_tr_b16 v[242:243], v251 offset:41984
    ds_read_b64_tr_b16 v[244:245], v252 offset:40960
    ds_read_b64_tr_b16 v[246:247], v252 offset:41984
    s_waitcnt lgkmcnt(4)
    v_mfma_f32_32x32x16_bf16 v[16:31], v[232:235], v[72:75], v[16:31]
    v_mfma_f32_32x32x16_bf16 v[32:47], v[236:239], v[72:75], v[32:47]
    ds_read_b64_tr_b16 v[232:233], v251 offset:49152
    ds_read_b64_tr_b16 v[234:235], v251 offset:50176
    ds_read_b64_tr_b16 v[236:237], v252 offset:49152
    ds_read_b64_tr_b16 v[238:239], v252 offset:50176
    s_waitcnt lgkmcnt(4)
    v_mfma_f32_32x32x16_bf16 v[16:31], v[240:243], v[76:79], v[16:31]
    v_mfma_f32_32x32x16_bf16 v[32:47], v[244:247], v[76:79], v[32:47]
    ds_read_b64_tr_b16 v[240:241], v251 offset:57344
    ds_read_b64_tr_b16 v[242:243], v251 offset:58368
    ds_read_b64_tr_b16 v[244:245], v252 offset:57344
    ds_read_b64_tr_b16 v[246:247], v252 offset:58368
    s_waitcnt lgkmcnt(4)
    v_mfma_f32_32x32x16_bf16 v[16:31], v[232:235], v[80:83], v[16:31]
    v_mfma_f32_32x32x16_bf16 v[32:47], v[236:239], v[80:83], v[32:47]
    s_waitcnt lgkmcnt(0)
    v_mfma_f32_32x32x16_bf16 v[16:31], v[240:243], v[84:87], v[16:31]
    v_mfma_f32_32x32x16_bf16 v[32:47], v[244:247], v[84:87], v[32:47]
    s_or_b32 s62, s26, s27
    s_cmp_lg_u32 s62, 0
    s_cbranch_scc1 L_noep
    s_lshl_b32 s62, s24, 5
    s_add_u32 s62, s62, s25
    s_lshl_b32 s62, s62, 2
    s_cmp_eq_u32 s25, 15
    s_cselect_b32 s63, 7, 1
    v_mov_b32 v11, s68
    v_writelane_b32 v11, s69, 1
    v_writelane_b32 v11, s70, 2
    s_mov_b32 s64, 1664525
    v_mul_lo_u32 v11, v11, s64
    v_add_u32 v11, 1013904223, v11
    v_lshlrev_b32 v12, 2, v0
    s_mov_b32 exec_lo, s63
    s_mov_b32 exec_hi, 0
    buffer_store_dword v11, v12, s[20:23], s62 offen
    s_mov_b64 exec, -1
L_noep:
    s_mov_b32 s61, 0
    s_waitcnt vmcnt(0)
L_s1:
    s_add_u32 s62, s76, 1024
    buffer_load_dwordx4 v[48:51], v10, s[20:23], s62 offen sc1
    s_add_u32 s62, s62, 4096
    buffer_load_dwordx4 v[52:55], v10, s[20:23], s62 offen sc1
    s_add_u32 s62, s62, 4096
    buffer_load_dwordx4 v[56:59], v10, s[20:23], s62 offen sc1
    s_add_u32 s62, s62, 4096
    buffer_load_dwordx4 v[60:63], v10, s[20:23], s62 offen sc1
    s_add_u32 s62, s62, 4096
    buffer_load_dwordx4 v[72:75], v10, s[20:23], s62 offen sc1
    s_add_u32 s62, s62, 4096
    buffer_load_dwordx4 v[76:79], v10, s[20:23], s62 offen sc1
    s_add_u32 s62, s62, 4096
    buffer_load_dwordx4 v[80:83], v10, s[20:23], s62 offen sc1
    s_add_u32 s62, s62, 4096
    buffer_load_dwordx4 v[84:87], v10, s[20:23], s62 offen sc1
    s_nop 7
    v_mov_b32 v144, v16
    v_mov_b32 v145, v17
    v_mov_b32 v146, v18
    v_mov_b32 v147, v19
    v_mov_b32 v148, v20
    v_mov_b32 v149, v21
    v_mov_b32 v150, v22
    v_mov_b32 v151, v23
    v_mov_b32 v152, v24
    v_mov_b32 v153, v25
    v_mov_b32 v154, v26
    v_mov_b32 v155, v27
    v_mov_b32 v156, v28
    v_mov_b32 v157, v29
    v_mov_b32 v158, v30
    v_mov_b32 v159, v31
    v_mov_b32 v160, v32
    v_mov_b32 v161, v33
    v_mov_b32 v162, v34
    v_mov_b32 v163, v35
    v_mov_b32 v164, v36
    v_mov_b32 v165, v37
    v_mov_b32 v166, v38
    v_mov_b32 v167, v39
    v_mov_b32 v168, v40
    v_mov_b32 v169, v41
    v_mov_b32 v170, v42
    v_mov_b32 v171, v43
    v_mov_b32 v172, v44
    v_mov_b32 v173, v45
    v_mov_b32 v174, v46
    v_mov_b32 v175, v47
    ds_read_b64_tr_b16 v[232:233], v251 offset:2048
    ds_read_b64_tr_b16 v[234:235], v251 offset:3072
    ds_read_b64_tr_b16 v[236:237], v252 offset:2048
    ds_read_b64_tr_b16 v[238:239], v252 offset:3072
    ds_read_b64_tr_b16 v[240:241], v251 offset:10240
    ds_read_b64_tr_b16 v[242:243], v251 offset:11264
    ds_read_b64_tr_b16 v[244:245], v252 offset:10240
    ds_read_b64_tr_b16 v[246:247], v252 offset:11264
    s_waitcnt vmcnt(7) lgkmcnt(4)
    v_mfma_f32_32x32x16_bf16 v[16:31], v[232:235], v[48:51], v[16:31]
    v_mfma_f32_32x32x16_bf16 v[32:47], v[236:239], v[48:51], v[32:47]
    v_max_u32 v14, v48, v49
    v_max3_u32 v14, v50, v51, v14
    ds_read_b64_tr_b16 v[232:233], v251 offset:18432
    ds_read_b64_tr_b16 v[234:235], v251 offset:19456
    ds_read_b64_tr_b16 v[236:237], v252 offset:18432
    ds_read_b64_tr_b16 v[238:239], v252 offset:19456
    s_waitcnt vmcnt(6) lgkmcnt(4)
    v_mfma_f32_32x32x16_bf16 v[16:31], v[240:243], v[52:55], v[16:31]
    v_mfma_f32_32x32x16_bf16 v[32:47], v[244:247], v[52:55], v[32:47]
    v_max3_u32 v14, v52, v53, v14
    v_max3_u32 v14, v54, v55, v14
    ds_read_b64_tr_b16 v[240:241], v251 offset:26624
    ds_read_b64_tr_b16 v[242:243], v251 offset:27648
    ds_read_b64_tr_b16 v[244:245], v252 offset:26624
    ds_read_b64_tr_b16 v[246:247], v252 offset:27648
    s_waitcnt vmcnt(5) lgkmcnt(4)
    v_mfma_f32_32x32x16_bf16 v[16:31], v[232:235], v[56:59], v[16:31]
    v_mfma_f32_32x32x16_bf16 v[32:47], v[236:239], v[56:59], v[32:47]
    v_max3_u32 v14, v56, v57, v14
    v_max3_u32 v14, v58, v59, v14
    ds_read_b64_tr_b16 v[232:233], v251 offset:34816
    ds_read_b64_tr_b16 v[234:235], v251 offset:35840
    ds_read_b64_tr_b16 v[236:237], v252 offset:34816
    ds_read_b64_tr_b16 v[238:239], v252 offset:35840
    s_waitcnt vmcnt(4) lgkmcnt(4)
    v_mfma_f32_32x32x16_bf16 v[16:31], v[240:243], v[60:63], v[16:31]
    v_mfma_f32_32x32x16_bf16 v[32:47], v[244:247], v[60:63], v[32:47]
    v_max3_u32 v14, v60, v61, v14
    v_max3_u32 v14, v62, v63, v14
    ds_read_b64_tr_b16 v[240:241], v251 offset:43008
    ds_read_b64_tr_b16 v[242:243], v251 offset:44032
    ds_read_b64_tr_b16 v[244:245], v252 offset:43008
    ds_read_b64_tr_b16 v[246:247], v252 offset:44032
    s_waitcnt vmcnt(3) lgkmcnt(4)
    v_mfma_f32_32x32x16_bf16 v[16:31], v[232:235], v[72:75], v[16:31]
    v_mfma_f32_32x32x16_bf16 v[32:47], v[236:239], v[72:75], v[32:47]
    v_max3_u32 v14, v72, v73, v14
    v_max3_u32 v14, v74, v75, v14
    ds_read_b64_tr_b16 v[232:233], v251 offset:51200
    ds_read_b64_tr_b16 v[234:235], v251 offset:52224
    ds_read_b64_tr_b16 v[236:237], v252 offset:51200
    ds_read_b64_tr_b16 v[238:239], v252 offset:52224
    s_waitcnt vmcnt(2) lgkmcnt(4)
    v_mfma_f32_32x32x16_bf16 v[16:31], v[240:243], v[76:79], v[16:31]
    v_mfma_f32_32x32x16_bf16 v[32:47], v[244:247], v[76:79], v[32:47]
    v_max3_u32 v14, v76, v77, v14
    v_max3_u32 v14, v78, v79, v14
    ds_read_b64_tr_b16 v[240:241], v251 offset:59392
    ds_read_b64_tr_b16 v[242:243], v251 offset:60416
    ds_read_b64_tr_b16 v[244:245], v252 offset:59392
    ds_read_b64_tr_b16 v[246:247], v252 offset:60416
    s_waitcnt vmcnt(1) lgkmcnt(4)
    v_mfma_f32_32x32x16_bf16 v[16:31], v[232:235], v[80:83], v[16:31]
    v_mfma_f32_32x32x16_bf16 v[32:47], v[236:239], v[80:83], v[32:47]
    v_max3_u32 v14, v80, v81, v14
    v_max3_u32 v14, v82, v83, v14
    s_waitcnt vmcnt(0) lgkmcnt(0)
    v_mfma_f32_32x32x16_bf16 v[16:31], v[240:243], v[84:87], v[16:31]
    v_mfma_f32_32x32x16_bf16 v[32:47], v[244:247], v[84:87], v[32:47]
    v_max3_u32 v14, v84, v85, v14
    v_max3_u32 v14, v86, v87, v14
    v_cmp_eq_u32 vcc, -1, v14
    s_cbranch_vccz L_s1ok
    s_nop 7
    s_nop 7
    v_mov_b32 v16, v144
    v_mov_b32 v17, v145
    v_mov_b32 v18, v146
    v_mov_b32 v19, v147
    v_mov_b32 v20, v148
    v_mov_b32 v21, v149
    v_mov_b32 v22, v150
    v_mov_b32 v23, v151
    v_mov_b32 v24, v152
    v_mov_b32 v25, v153
    v_mov_b32 v26, v154
    v_mov_b32 v27, v155
    v_mov_b32 v28, v156
    v_mov_b32 v29, v157
    v_mov_b32 v30, v158
    v_mov_b32 v31, v159
    v_mov_b32 v32, v160
    v_mov_b32 v33, v161
    v_mov_b32 v34, v162
    v_mov_b32 v35, v163
    v_mov_b32 v36, v164
    v_mov_b32 v37, v165
    v_mov_b32 v38, v166
    v_mov_b32 v39, v167
    v_mov_b32 v40, v168
    v_mov_b32 v41, v169
    v_mov_b32 v42, v170
    v_mov_b32 v43, v171
    v_mov_b32 v44, v172
    v_mov_b32 v45, v173
    v_mov_b32 v46, v174
    v_mov_b32 v47, v175
    v_lshlrev_b32 v11, 9, v253
    s_add_u32 s62, s76, 2044
L_s1p:
    buffer_load_dword v12, v11, s[20:23], s62 offen sc1
    s_add_u32 s61, s61, 1
    s_cmp_ge_u32 s61, 0x400000
    s_cbranch_scc1 L_s1ok
    s_waitcnt vmcnt(0)
    v_cmp_eq_u32 vcc, -1, v12
    s_cbranch_vccnz L_s1p
    s_branch L_s1
L_s1ok:
    s_lshl_b32 s62, s27, 12
    s_add_u32 s62, s62, 65536
    v_add_u32 v11, s62, v10
    s_sub_u32 s63, 7, s27
    s_lshl_b32 s63, s63, 12
    s_add_u32 s63, s63, 65536
    v_add_u32 v12, s63, v10
    s_lshl_b32 s62, s25, 2
    s_add_u32 s62, s62, s28
    s_lshl_b32 s62, s62, 16
    s_lshl_b32 s63, s24, 10
    s_add_u32 s62, s62, s63
    s_lshl_b32 s63, s26, 7
    s_add_u32 s62, s62, s63
    s_lshl_b32 s63, s29, 6
    s_add_u32 s62, s62, s63
    v_and_b32 v13, 31, v0
    v_lshlrev_b32 v13, 11, v13
    v_lshrrev_b32 v14, 5, v0
    v_lshl_add_u32 v13, v14, 5, v13
    s_cmp_eq_u32 s29, 0
    s_cbranch_scc1 L_red0
    s_nop 3
    ds_write_b128 v11, v[16:19] offset:0
    ds_write_b128 v11, v[20:23] offset:1024
    ds_write_b128 v11, v[24:27] offset:2048
    ds_write_b128 v11, v[28:31] offset:3072
    s_waitcnt lgkmcnt(0)
    s_barrier
    ds_read_b128 v[144:147], v12 offset:0
    ds_read_b128 v[148:151], v12 offset:1024
    ds_read_b128 v[152:155], v12 offset:2048
    ds_read_b128 v[156:159], v12 offset:3072
    s_waitcnt lgkmcnt(3)
    v_add_f32 v32, v32, v144
    v_add_f32 v33, v33, v145
    v_add_f32 v34, v34, v146
    v_add_f32 v35, v35, v147
    s_waitcnt lgkmcnt(2)
    v_add_f32 v36, v36, v148
    v_add_f32 v37, v37, v149
    v_add_f32 v38, v38, v150
    v_add_f32 v39, v39, v151
    s_waitcnt lgkmcnt(1)
    v_add_f32 v40, v40, v152
    v_add_f32 v41, v41, v153
    v_add_f32 v42, v42, v154
    v_add_f32 v43, v43, v155
    s_waitcnt lgkmcnt(0)
    v_add_f32 v44, v44, v156
    v_add_f32 v45, v45, v157
    v_add_f32 v46, v46, v158
    v_add_f32 v47, v47, v159
    v_cvt_pk_bf16_f32 v32, v32, v33
    v_cvt_pk_bf16_f32 v33, v34, v35
    v_cvt_pk_bf16_f32 v34, v36, v37
    v_cvt_pk_bf16_f32 v35, v38, v39
    v_cvt_pk_bf16_f32 v36, v40, v41
    v_cvt_pk_bf16_f32 v37, v42, v43
    v_cvt_pk_bf16_f32 v38, v44, v45
    v_cvt_pk_bf16_f32 v39, v46, v47
    buffer_store_dwordx4 v[32:35], v13, s[16:19], s62 offen
    buffer_store_dwordx4 v[36:39], v13, s[16:19], s62 offen offset:16
    s_branch L_stored
L_red0:
    s_nop 3
    ds_write_b128 v11, v[32:35] offset:0
    ds_write_b128 v11, v[36:39] offset:1024
    ds_write_b128 v11, v[40:43] offset:2048
    ds_write_b128 v11, v[44:47] offset:3072
    s_waitcnt lgkmcnt(0)
    s_barrier
    ds_read_b128 v[144:147], v12 offset:0
    ds_read_b128 v[148:151], v12 offset:1024
    ds_read_b128 v[152:155], v12 offset:2048
    ds_read_b128 v[156:159], v12 offset:3072
    s_waitcnt lgkmcnt(3)
    v_add_f32 v16, v16, v144
    v_add_f32 v17, v17, v145
    v_add_f32 v18, v18, v146
    v_add_f32 v19, v19, v147
    s_waitcnt lgkmcnt(2)
    v_add_f32 v20, v20, v148
    v_add_f32 v21, v21, v149
    v_add_f32 v22, v22, v150
    v_add_f32 v23, v23, v151
    s_waitcnt lgkmcnt(1)
    v_add_f32 v24, v24, v152
    v_add_f32 v25, v25, v153
    v_add_f32 v26, v26, v154
    v_add_f32 v27, v27, v155
    s_waitcnt lgkmcnt(0)
    v_add_f32 v28, v28, v156
    v_add_f32 v29, v29, v157
    v_add_f32 v30, v30, v158
    v_add_f32 v31, v31, v159
    v_cvt_pk_bf16_f32 v16, v16, v17
    v_cvt_pk_bf16_f32 v17, v18, v19
    v_cvt_pk_bf16_f32 v18, v20, v21
    v_cvt_pk_bf16_f32 v19, v22, v23
    v_cvt_pk_bf16_f32 v20, v24, v25
    v_cvt_pk_bf16_f32 v21, v26, v27
    v_cvt_pk_bf16_f32 v22, v28, v29
    v_cvt_pk_bf16_f32 v23, v30, v31
    buffer_store_dwordx4 v[16:19], v13, s[16:19], s62 offen
    buffer_store_dwordx4 v[20:23], v13, s[16:19], s62 offen offset:16
L_stored:
L_end:
    s_endpgm
L_x0_0:
    s_waitcnt lgkmcnt(0)
    s_nop 0
    v_mfma_f32_32x32x16_bf16 v[216:231], v[200:203], v[176:179], 0
    v_mfma_f32_32x32x16_bf16 v[216:231], v[204:207], v[180:183], v[216:231]
    s_branch L_fin0
L_x0_1:
    s_waitcnt lgkmcnt(0)
    s_nop 0
    v_mfma_f32_32x32x16_bf16 v[216:231], v[208:211], v[184:187], v[216:231]
    v_mfma_f32_32x32x16_bf16 v[216:231], v[212:215], v[188:191], v[216:231]
    s_branch L_fin0
L_x0_2:
    s_waitcnt lgkmcnt(0)
    s_nop 0
    v_mfma_f32_32x32x16_bf16 v[216:231], v[200:203], v[176:179], v[216:231]
    v_mfma_f32_32x32x16_bf16 v[216:231], v[204:207], v[180:183], v[216:231]
    s_branch L_fin0
L_x0_3:
    s_waitcnt lgkmcnt(0)
    s_nop 0
    v_mfma_f32_32x32x16_bf16 v[216:231], v[208:211], v[184:187], v[216:231]
    v_mfma_f32_32x32x16_bf16 v[216:231], v[212:215], v[188:191], v[216:231]
    s_branch L_fin0
L_x0_4:
    s_waitcnt lgkmcnt(0)
    s_nop 0
    v_mfma_f32_32x32x16_bf16 v[216:231], v[200:203], v[176:179], v[216:231]
    v_mfma_f32_32x32x16_bf16 v[216:231], v[204:207], v[180:183], v[216:231]
    s_branch L_fin0
L_x0_5:
    s_waitcnt lgkmcnt(0)
    s_nop 0
    v_mfma_f32_32x32x16_bf16 v[216:231], v[208:211], v[184:187], v[216:231]
    v_mfma_f32_32x32x16_bf16 v[216:231], v[212:215], v[188:191], v[216:231]
    s_branch L_fin0
L_x0_6:
    s_waitcnt lgkmcnt(0)
    s_nop 0
    v_mfma_f32_32x32x16_bf16 v[216:231], v[200:203], v[176:179], v[216:231]
    v_mfma_f32_32x32x16_bf16 v[216:231], v[204:207], v[180:183], v[216:231]
    s_branch L_fin0
L_x0_7:
    s_waitcnt lgkmcnt(0)
    s_nop 0
    v_mfma_f32_32x32x16_bf16 v[216:231], v[208:211], v[184:187], v[216:231]
    v_mfma_f32_32x32x16_bf16 v[216:231], v[212:215], v[188:191], v[216:231]
    s_branch L_fin0
L_fb0:
    s_cmp_eq_u32 s60, 1
    s_cbranch_scc1 L_fbdone0
    s_mov_b32 s60, 1
    v_mfma_f32_32x32x16_bf16 v[144:159], v[120:123], v[64:67], v[88:103]
    v_mov_b32 v11, 0xff7fffff
    v_mov_b32 v13, v248
    s_mov_b32 s61, 0
L_fbl0:
    s_nop 15
    v_max3_f32 v11, v144, v145, v11
    v_max3_f32 v11, v146, v147, v11
    v_max3_f32 v11, v148, v149, v11
    v_max3_f32 v11, v150, v151, v11
    v_max3_f32 v11, v152, v153, v11
    v_max3_f32 v11, v154, v155, v11
    v_max3_f32 v11, v156, v157, v11
    v_max3_f32 v11, v158, v159, v11
    s_cmp_eq_u32 s61, s59
    s_cbranch_scc1 L_fbm0
    s_add_u32 s61, s61, 1
    ds_read_b128 v[192:195], v13
    v_add_u32 v13, 8192, v13
    s_waitcnt lgkmcnt(0)
    s_cmp_eq_u32 s61, 8
    s_cbranch_scc1 L_fbf0
    v_mfma_f32_32x32x16_bf16 v[144:159], v[192:195], v[64:67], 0
    s_branch L_fbl0
L_fbf0:
    v_mfma_f32_32x32x16_bf16 v[144:159], v[192:195], v[64:67], v[104:119]
    s_branch L_fbl0
L_fbm0:
    v_mov_b32 v12, v11
    s_nop 1
    v_permlane32_swap_b32 v11, v12
    s_nop 1
    v_max_f32 v11, v11, v12
    v_sub_f32 v88, v88, v11
    v_sub_f32 v104, v104, v11
    v_sub_f32 v128, 0, v11
    v_sub_f32 v89, v89, v11
    v_sub_f32 v105, v105, v11
    v_sub_f32 v129, 0, v11
    v_sub_f32 v90, v90, v11
    v_sub_f32 v106, v106, v11
    v_sub_f32 v130, 0, v11
    v_sub_f32 v91, v91, v11
    v_sub_f32 v107, v107, v11
    v_sub_f32 v131, 0, v11
    v_sub_f32 v92, v92, v11
    v_sub_f32 v108, v108, v11
    v_sub_f32 v132, 0, v11
    v_sub_f32 v93, v93, v11
    v_sub_f32 v109, v109, v11
    v_sub_f32 v133, 0, v11
    v_sub_f32 v94, v94, v11
    v_sub_f32 v110, v110, v11
    v_sub_f32 v134, 0, v11
    v_sub_f32 v95, v95, v11
    v_sub_f32 v111, v111, v11
    v_sub_f32 v135, 0, v11
    v_sub_f32 v96, v96, v11
    v_sub_f32 v112, v112, v11
    v_sub_f32 v136, 0, v11
    v_sub_f32 v97, v97, v11
    v_sub_f32 v113, v113, v11
    v_sub_f32 v137, 0, v11
    v_sub_f32 v98, v98, v11
    v_sub_f32 v114, v114, v11
    v_sub_f32 v138, 0, v11
    v_sub_f32 v99, v99, v11
    v_sub_f32 v115, v115, v11
    v_sub_f32 v139, 0, v11
    v_sub_f32 v100, v100, v11
    v_sub_f32 v116, v116, v11
    v_sub_f32 v140, 0, v11
    v_sub_f32 v101, v101, v11
    v_sub_f32 v117, v117, v11
    v_sub_f32 v141, 0, v11
    v_sub_f32 v102, v102, v11
    v_sub_f32 v118, v118, v11
    v_sub_f32 v142, 0, v11
    v_sub_f32 v103, v103, v11
    v_sub_f32 v119, v119, v11
    v_sub_f32 v143, 0, v11
    s_nop 1
    s_branch L_att0
L_fbdone0:
    s_branch L_ok0
L_x1_0:
    s_waitcnt lgkmcnt(0)
    s_nop 0
    v_mfma_f32_32x32x16_bf16 v[216:231], v[200:203], v[176:179], 0
    v_mfma_f32_32x32x16_bf16 v[216:231], v[204:207], v[180:183], v[216:231]
    s_branch L_fin1
L_x1_1:
    s_waitcnt lgkmcnt(0)
    s_nop 0
    v_mfma_f32_32x32x16_bf16 v[216:231], v[208:211], v[184:187], v[216:231]
    v_mfma_f32_32x32x16_bf16 v[216:231], v[212:215], v[188:191], v[216:231]
    s_branch L_fin1
L_x1_2:
    s_waitcnt lgkmcnt(0)
    s_nop 0
    v_mfma_f32_32x32x16_bf16 v[216:231], v[200:203], v[176:179], v[216:231]
    v_mfma_f32_32x32x16_bf16 v[216:231], v[204:207], v[180:183], v[216:231]
    s_branch L_fin1
L_x1_3:
    s_waitcnt lgkmcnt(0)
    s_nop 0
    v_mfma_f32_32x32x16_bf16 v[216:231], v[208:211], v[184:187], v[216:231]
    v_mfma_f32_32x32x16_bf16 v[216:231], v[212:215], v[188:191], v[216:231]
    s_branch L_fin1
L_x1_4:
    s_waitcnt lgkmcnt(0)
    s_nop 0
    v_mfma_f32_32x32x16_bf16 v[216:231], v[200:203], v[176:179], v[216:231]
    v_mfma_f32_32x32x16_bf16 v[216:231], v[204:207], v[180:183], v[216:231]
    s_branch L_fin1
L_x1_5:
    s_waitcnt lgkmcnt(0)
    s_nop 0
    v_mfma_f32_32x32x16_bf16 v[216:231], v[208:211], v[184:187], v[216:231]
    v_mfma_f32_32x32x16_bf16 v[216:231], v[212:215], v[188:191], v[216:231]
    s_branch L_fin1
L_x1_6:
    s_waitcnt lgkmcnt(0)
    s_nop 0
    v_mfma_f32_32x32x16_bf16 v[216:231], v[200:203], v[176:179], v[216:231]
    v_mfma_f32_32x32x16_bf16 v[216:231], v[204:207], v[180:183], v[216:231]
    s_branch L_fin1
L_x1_7:
    s_waitcnt lgkmcnt(0)
    s_nop 0
    v_mfma_f32_32x32x16_bf16 v[216:231], v[208:211], v[184:187], v[216:231]
    v_mfma_f32_32x32x16_bf16 v[216:231], v[212:215], v[188:191], v[216:231]
    s_branch L_fin1
L_fb1:
    s_cmp_eq_u32 s60, 1
    s_cbranch_scc1 L_fbdone1
    s_mov_b32 s60, 1
    v_mfma_f32_32x32x16_bf16 v[144:159], v[124:127], v[68:71], v[88:103]
    v_mov_b32 v11, 0xff7fffff
    v_mov_b32 v13, v248
    s_mov_b32 s61, 0
L_fbl1:
    s_nop 15
    v_max3_f32 v11, v144, v145, v11
    v_max3_f32 v11, v146, v147, v11
    v_max3_f32 v11, v148, v149, v11
    v_max3_f32 v11, v150, v151, v11
    v_max3_f32 v11, v152, v153, v11
    v_max3_f32 v11, v154, v155, v11
    v_max3_f32 v11, v156, v157, v11
    v_max3_f32 v11, v158, v159, v11
    s_cmp_eq_u32 s61, s59
    s_cbranch_scc1 L_fbm1
    s_add_u32 s61, s61, 1
    ds_read_b128 v[192:195], v13
    v_add_u32 v13, 8192, v13
    s_waitcnt lgkmcnt(0)
    s_cmp_eq_u32 s61, 8
    s_cbranch_scc1 L_fbf1
    v_mfma_f32_32x32x16_bf16 v[144:159], v[192:195], v[68:71], 0
    s_branch L_fbl1
L_fbf1:
    v_mfma_f32_32x32x16_bf16 v[144:159], v[192:195], v[68:71], v[104:119]
    s_branch L_fbl1
L_fbm1:
    v_mov_b32 v12, v11
    s_nop 1
    v_permlane32_swap_b32 v11, v12
    s_nop 1
    v_max_f32 v11, v11, v12
    v_sub_f32 v88, v88, v11
    v_sub_f32 v104, v104, v11
    v_sub_f32 v128, 0, v11
    v_sub_f32 v89, v89, v11
    v_sub_f32 v105, v105, v11
    v_sub_f32 v129, 0, v11
    v_sub_f32 v90, v90, v11
    v_sub_f32 v106, v106, v11
    v_sub_f32 v130, 0, v11
    v_sub_f32 v91, v91, v11
    v_sub_f32 v107, v107, v11
    v_sub_f32 v131, 0, v11
    v_sub_f32 v92, v92, v11
    v_sub_f32 v108, v108, v11
    v_sub_f32 v132, 0, v11
    v_sub_f32 v93, v93, v11
    v_sub_f32 v109, v109, v11
    v_sub_f32 v133, 0, v11
    v_sub_f32 v94, v94, v11
    v_sub_f32 v110, v110, v11
    v_sub_f32 v134, 0, v11
    v_sub_f32 v95, v95, v11
    v_sub_f32 v111, v111, v11
    v_sub_f32 v135, 0, v11
    v_sub_f32 v96, v96, v11
    v_sub_f32 v112, v112, v11
    v_sub_f32 v136, 0, v11
    v_sub_f32 v97, v97, v11
    v_sub_f32 v113, v113, v11
    v_sub_f32 v137, 0, v11
    v_sub_f32 v98, v98, v11
    v_sub_f32 v114, v114, v11
    v_sub_f32 v138, 0, v11
    v_sub_f32 v99, v99, v11
    v_sub_f32 v115, v115, v11
    v_sub_f32 v139, 0, v11
    v_sub_f32 v100, v100, v11
    v_sub_f32 v116, v116, v11
    v_sub_f32 v140, 0, v11
    v_sub_f32 v101, v101, v11
    v_sub_f32 v117, v117, v11
    v_sub_f32 v141, 0, v11
    v_sub_f32 v102, v102, v11
    v_sub_f32 v118, v118, v11
    v_sub_f32 v142, 0, v11
    v_sub_f32 v103, v103, v11
    v_sub_f32 v119, v119, v11
    v_sub_f32 v143, 0, v11
    s_nop 1
    s_branch L_att1
L_fbdone1:
    s_branch L_ok1
L_last:
    s_endpgm
.section .rodata,"a"
.p2align 6
.amdhsa_kernel concat_heads__sliding_block__sliding_block__prompt_kernel
  .amdhsa_next_free_vgpr 256
  .amdhsa_next_free_sgpr 102
  .amdhsa_accum_offset 256
  .amdhsa_group_segment_fixed_size 0
  .amdhsa_kernarg_size 72
  .amdhsa_user_sgpr_count 2
  .amdhsa_user_sgpr_kernarg_segment_ptr 1
  .amdhsa_system_sgpr_workgroup_id_x 1
.end_amdhsa_kernel
```
